```python
import torch

def _softmax(x, axis=-1):
    return torch.softmax(x, dim=axis)
def _gelu(x):
    return torch.nn.functional.gelu(x, approximate="tanh")
def _silu(x):
    return torch.nn.functional.silu(x)
def _sigmoid(x):
    return torch.sigmoid(x)
def _layernorm(x, axis=-1, eps=1e-5):
    m = x.mean(dim=axis, keepdim=True)
    v = x.var(dim=axis, keepdim=True, unbiased=False)
    return (x - m) / torch.sqrt(v + eps)
def _scatter_add(tgt, idx, src, axis=0):
    return tgt.clone().index_add_(axis, idx, src)
def _segment_sum(src, seg, n):
    out = torch.zeros((n,) + src.shape[1:], dtype=src.dtype)
    return out.index_add_(0, seg, src)
def _pad(x, pw):
    flat = tuple(v for pair in reversed(pw) for v in pair)
    return torch.nn.functional.pad(x, flat)

kernel_name = 'interleave_layers__sliding_block_cached__glu_gated_bilinear__decode'

def setup_inputs():

    _w = (lambda a: (lambda t: t.to(torch.bfloat16) if t.is_floating_point() else t)(torch.as_tensor(a)))
    def _A_setup():
        B, Sq, D = 1, 1, 512
        Hq, Hkv, Sk, Dh = 32, 8, 65536, 128
        assert Hq % Hkv == 0, (Hq, Hkv)
        return {
            "x": _w((lambda *s: torch.randn(*s, dtype=torch.bfloat16) * 0.05)(B, Sq, D)),
            "k_cache": _w((lambda *s: torch.randn(*s, dtype=torch.bfloat16) * 0.8)(B, Hkv, Sk, Dh)),
            "v_cache": _w((lambda *s: torch.randn(*s, dtype=torch.bfloat16) * 0.8)(B, Hkv, Sk, Dh)),
            "wq": _w((lambda *s: torch.randn(*s, dtype=torch.bfloat16) * 0.8)(D, Hq * Dh) * (D ** -0.5)),
            "wo": _w((lambda *s: torch.randn(*s, dtype=torch.bfloat16) * 0.8)(Hq * Dh, D) * ((Hq * Dh) ** -0.5)),
        }
    _A_in = _A_setup()

    def _B_setup():
        B, S, D, F = 1, 1, 512, 1792
        return {
            "x": _w((lambda *s: torch.randn(*s, dtype=torch.bfloat16) * 0.05)(B, S, D)),
            "w_gate": _w((lambda *s: torch.randn(*s, dtype=torch.bfloat16) * 0.2)(D, F) * (D ** -0.5)),
            "w_up": _w((lambda *s: torch.randn(*s, dtype=torch.bfloat16) * 0.2)(D, F) * (D ** -0.5)),
            "w_down": _w((lambda *s: torch.randn(*s, dtype=torch.bfloat16) * 0.2)(F, D) * (F ** -0.5)),
        }
    _B_in = _B_setup()

    return {
        "A_x": _A_in["x"],
        "A_k_cache": _A_in["k_cache"],
        "A_v_cache": _A_in["v_cache"],
        "A_wq": _A_in["wq"],
        "A_wo": _A_in["wo"],
        "B_x": _B_in["x"],
        "B_w_gate": _B_in["w_gate"],
        "B_w_up": _B_in["w_up"],
        "B_w_down": _B_in["w_down"],
    }

def reference(A_x, A_k_cache, A_v_cache, A_wq, A_wo, B_x, B_w_gate, B_w_up, B_w_down):
    def _A_ref(x, k_cache, v_cache, wq, wo):
        B, Sq, D = x.shape
        Hq, Dh = 32, 128
        Hkv, Sk = k_cache.shape[1], k_cache.shape[2]
        W = min(4096, max(256, Sk // 4))
        rep = Hq // Hkv
        q = (lambda x, *d: x.permute(*d))((x @ wq).reshape(B, Sq, Hq, Dh), 0, 2, 1, 3)
        k = (lambda x, n, axis: torch.repeat_interleave(x, n, dim=axis))(k_cache[:, :, Sk - W:, :], rep, axis=1)
        v = (lambda x, n, axis: torch.repeat_interleave(x, n, dim=axis))(v_cache[:, :, Sk - W:, :], rep, axis=1)
        scores = torch.einsum("bhqd,bhkd->bhqk", q, k) * (Dh ** -0.5)
        p = _softmax(scores, axis=-1)
        o = torch.einsum("bhqk,bhkd->bhqd", p, v)
        return (lambda x, *d: x.permute(*d))(o, 0, 2, 1, 3).reshape(B, Sq, Hq * Dh) @ wo

    def _B_ref(x, w_gate, w_up, w_down):
        g = torch.einsum("bsd,df->bsf", x, w_gate)
        u = torch.einsum("bsd,df->bsf", x, w_up)
        h = g * u
        return torch.einsum("bsf,fd->bsd", h, w_down)

    x = A_x
    x = x + _A_ref(_layernorm(x, axis=-1), A_k_cache, A_v_cache, A_wq, A_wo)
    x = x + _B_ref(_layernorm(x, axis=-1), B_w_gate, B_w_up, B_w_down)
    x = x + _A_ref(_layernorm(x, axis=-1), A_k_cache, A_v_cache, A_wq, A_wo)
    x = x + _B_ref(_layernorm(x, axis=-1), B_w_gate, B_w_up, B_w_down)
    return x
```

```asm
; @launch grid=(256,1,1) block=(384,1,1) lds=116736
.amdgcn_target "amdgcn-amd-amdhsa--gfx950"
.text
.globl interleave_layers__sliding_block_cached__glu_gated_bilinear__decode_kernel
.p2align 8
.type interleave_layers__sliding_block_cached__glu_gated_bilinear__decode_kernel,@function
interleave_layers__sliding_block_cached__glu_gated_bilinear__decode_kernel:
  s_load_dwordx16 s[4:19], s[0:1], 0
  s_load_dwordx8 s[20:27], s[0:1], 64
  s_cmpk_ge_u32 s2, 0x100
  s_cbranch_scc1 L_exit
  v_lshrrev_b32 v1, 6, v0
  v_and_b32 v0, 63, v0
  s_lshr_b32 s29, s2, 3
  v_readfirstlane_b32 s33, v1
  s_and_b32 s28, s2, 7
  s_lshl_b32 s60, s29, 4
  v_lshlrev_b32 v15, 4, v0
  s_cmp_ge_u32 s33, 4
  s_cbranch_scc1 L_C0
  s_lshl2_add_u32 s32, s33, s60
  s_lshl3_add_u32 s30, s32, s28
  s_lshl_b32 s30, s30, 10
  v_add_u32 v1, s30, v15
  s_lshl_b32 s36, s33, 12
  s_add_u32 m0, s36, 43008
  s_movk_i32 s3, 0x2000
  s_waitcnt lgkmcnt(0)
  global_load_lds_dwordx4 v1, s[10:11] nt
  s_addk_i32 m0, 0x400
  v_add_u32 v1, s3, v1
  global_load_lds_dwordx4 v1, s[10:11] nt
  s_addk_i32 m0, 0x400
  v_add_u32 v1, s3, v1
  global_load_lds_dwordx4 v1, s[10:11] nt
  s_addk_i32 m0, 0x400
  v_add_u32 v1, s3, v1
  global_load_lds_dwordx4 v1, s[10:11] nt
  s_branch L_S1
L_C0:
  s_cmp_eq_u32 s33, 4
  s_cbranch_scc1 L_X0
  s_getpc_b64 s[30:31]
  s_mulk_i32 s29, 768
  v_lshl_add_u32 v2, v0, 7, s29
  s_mov_b64 exec, 63
  global_load_dword v211, v2, s[30:31]
  s_branch L_C
L_X0:
  s_setprio 3
  s_waitcnt lgkmcnt(0)
  global_load_dwordx4 v[32:35], v15, s[4:5]
  s_branch L_C
L_early_end:
L_S1:
  s_lshl_b32 s30, s28, 24
  s_lshl_b32 s31, s29, 15
  s_add_u32 s30, s30, s31
  s_add_u32 s30, s30, 0xF00000
  s_add_u32 s6, s6, s30
  s_addc_u32 s7, s7, 0
  s_lshl_b32 s40, s33, 13
  s_mov_b32 m0, s40
  v_and_b32 v6, 15, v0
  v_lshrrev_b32 v7, 4, v0
  v_xor_b32 v8, v6, v7
  v_lshlrev_b32 v8, 4, v8
  v_lshl_add_u32 v9, v7, 8, v8
  v_add_u32 v9, s40, v9
  s_lshl_b32 s37, s29, 2
  s_and_b32 s31, s28, 3
  s_or_b32 s37, s37, s31
  s_lshl_b32 s37, s37, 8
  v_xor_b32 v9, s37, v9
  s_waitcnt vmcnt(3)
  global_load_lds_dwordx4 v9, s[6:7] nt
  s_addk_i32 m0, 0x400
  v_xor_b32 v1, 1088, v9
  s_waitcnt vmcnt(3)
  global_load_lds_dwordx4 v1, s[6:7] nt
  s_addk_i32 m0, 0x400
  v_xor_b32 v1, 2176, v9
  s_waitcnt vmcnt(3)
  global_load_lds_dwordx4 v1, s[6:7] nt
  s_addk_i32 m0, 0x400
  v_xor_b32 v1, 3264, v9
  s_waitcnt vmcnt(3)
  s_barrier
  global_load_lds_dwordx4 v1, s[6:7] nt
  s_add_u32 s8, s8, s30
  s_addc_u32 s9, s9, 0
  s_mov_b32 s62, 0x05040100
  s_mov_b32 s63, 0x07060302
  s_mov_b32 s64, 0x3f803f80
  v_lshlrev_b32 v10, 1, v7
  v_xor_b32 v10, v10, v6
  v_lshlrev_b32 v10, 4, v10
  v_lshl_add_u32 v10, v7, 8, v10
  v_add_u32 v10, s40, v10
  v_xor_b32 v10, s37, v10
  v_lshl_add_u32 v11, v6, 8, v8
  v_add_u32 v11, s40, v11
  v_xor_b32 v12, 64, v11
  v_xor_b32 v13, 128, v11
  v_xor_b32 v14, 192, v11
  v_lshrrev_b32 v2, 2, v6
  v_lshlrev_b32 v5, 4, v2
  v_lshlrev_b32 v2, 8, v2
  v_lshl_add_u32 v2, v7, 4, v2
  s_lshl_b32 s31, s33, 2
  s_add_u32 s31, s31, 40960
  v_add_u32 v5, s31, v5
  v_lshlrev_b32 v3, 4, v7
  v_add_u32 v3, 40960, v3
  s_lshl_b32 s31, s33, 10
  s_add_u32 s31, s31, 32768
  v_add_u32 v4, s31, v15
  v_bfe_u32 v192, v0, 2, 4
  v_and_b32 v193, 7, v192
  v_lshlrev_b32 v193, 1, v193
  v_bfe_u32 v194, v0, 1, 1
  s_lshl_b32 s31, s33, 2
  v_add_u32 v194, s31, v194
  v_xor_b32 v193, v193, v194
  v_lshlrev_b32 v193, 4, v193
  v_lshl_add_u32 v193, v192, 8, v193
  v_and_b32 v194, 1, v0
  v_lshl_add_u32 v193, v194, 3, v193
  v_xor_b32 v207, 32, v193
  v_add_u32 v206, 83968, v193
  v_add_u32 v207, 83968, v207
  v_lshl_add_u32 v195, v7, 2, s33
  v_mul_u32_u24 v192, 6144, v195
  v_lshl_add_u32 v192, v194, 5, v192
  v_lshrrev_b32 v194, 1, v6
  v_xor_b32 v194, v194, v195
  v_and_b32 v194, 7, v194
  v_lshl_add_u32 v192, v194, 2, v192
  s_lshl_b32 s31, s29, 6
  v_add_u32 v208, s31, v192
  s_mul_i32 s31, s28, 196608
  s_add_u32 s31, s31, 1050624
  s_add_u32 s42, s26, s31
  s_addc_u32 s43, s27, 0
  s_addk_i32 m0, 0x400
  v_xor_b32 v1, 4096, v9
  s_waitcnt vmcnt(3)
  global_load_lds_dwordx4 v1, s[6:7] nt
  v_mov_b32 v140, s64
  v_mov_b32 v141, s64
  v_mov_b32 v142, s64
  v_mov_b32 v143, s64
  v_mov_b32 v198, 0x3e0293ee
  v_mov_b32 v199, 0x3e0293ee
  v_mov_b32 v197, 0x42700000
  v_mov_b32 v204, 0
  v_add_u32 v2, 41984, v2
  v_lshrrev_b32 v192, 2, v6
  v_add_u32 v193, 0, v192
  v_and_b32 v193, 3, v193
  v_lshl_add_u32 v200, v193, 6, v2
  v_add_u32 v193, 1, v192
  v_and_b32 v193, 3, v193
  v_lshl_add_u32 v201, v193, 6, v2
  v_add_u32 v193, 2, v192
  v_and_b32 v193, 3, v193
  v_lshl_add_u32 v202, v193, 6, v2
  v_add_u32 v193, 3, v192
  v_and_b32 v193, 3, v193
  v_lshl_add_u32 v203, v193, 6, v2
  s_addk_i32 m0, 0x400
  v_xor_b32 v1, 5184, v9
  s_waitcnt vmcnt(3)
  global_load_lds_dwordx4 v1, s[6:7] nt
  s_mul_i32 s30, s32, 3584
  s_mul_i32 s31, s28, 448
  s_add_u32 s30, s30, s31
  v_and_b32 v184, 31, v0
  v_lshl_add_u32 v184, v184, 4, s30
  v_cmp_gt_u32 vcc, 32, v0
  v_mov_b32 v186, s18
  v_mov_b32 v187, s19
  v_mov_b32 v188, s16
  v_mov_b32 v189, s17
  v_cndmask_b32 v186, v186, v188, vcc
  v_cndmask_b32 v187, v187, v189, vcc
  v_mov_b32 v185, 0
  s_mov_b32 s14, 3584
  s_mov_b32 s15, 0
  v_lshl_add_u64 v[184:185], v[184:185], 0, v[186:187]
  s_min_u32 s30, s29, 27
  s_mul_i32 s31, s28, 224
  s_lshl3_add_u32 s30, s30, s31
  s_lshl1_add_u32 s30, s33, s30
  s_lshl_b32 s30, s30, 10
  v_add_u32 v190, s30, v15
  s_addk_i32 m0, 0x400
  v_xor_b32 v1, 6272, v9
  s_waitcnt vmcnt(3)
  global_load_lds_dwordx4 v1, s[6:7] nt
  s_addk_i32 m0, 0x400
  v_xor_b32 v1, 7360, v9
  s_waitcnt vmcnt(3)
  global_load_lds_dwordx4 v1, s[6:7] nt
  s_add_u32 m0, s40, 83968
  s_waitcnt vmcnt(3)
  global_load_lds_dwordx4 v10, s[8:9] nt
  s_addk_i32 m0, 0x400
  v_xor_b32 v1, 1152, v10
  s_waitcnt vmcnt(3)
  global_load_lds_dwordx4 v1, s[8:9] nt
  s_addk_i32 m0, 0x400
  v_xor_b32 v1, 2048, v10
  s_waitcnt vmcnt(3)
  global_load_lds_dwordx4 v1, s[8:9] nt
  s_addk_i32 m0, 0x400
  v_xor_b32 v1, 3200, v10
  s_waitcnt vmcnt(3)
  global_load_lds_dwordx4 v1, s[8:9] nt
  s_addk_i32 m0, 0x400
  v_xor_b32 v1, 4096, v10
  s_waitcnt vmcnt(3)
  global_load_lds_dwordx4 v1, s[8:9] nt
  s_addk_i32 m0, 0x400
  v_xor_b32 v1, 5248, v10
  s_waitcnt vmcnt(3)
  global_load_lds_dwordx4 v1, s[8:9] nt
  s_addk_i32 m0, 0x400
  v_xor_b32 v1, 6144, v10
  global_load_lds_dwordx4 v1, s[8:9] nt
  s_addk_i32 m0, 0x400
  v_xor_b32 v1, 7296, v10
  s_waitcnt vmcnt(4)
  global_load_lds_dwordx4 v1, s[8:9] nt
  ds_read_b128 v[16:19], v11 offset:0
  ds_read_b128 v[20:23], v12 offset:0
  ds_read_b128 v[24:27], v13 offset:0
  ds_read_b128 v[28:31], v14 offset:0
  ds_read_b128 v[32:35], v11 offset:4096
  ds_read_b128 v[36:39], v12 offset:4096
  ds_read_b128 v[40:43], v13 offset:4096
  ds_read_b128 v[44:47], v14 offset:4096
  s_add_u32 m0, s36, 59392
  s_waitcnt vmcnt(4)
  s_mov_b32 exec_lo, 0x0fffffff
  s_mov_b32 exec_hi, 0x0fffffff
  global_load_lds_dwordx4 v[184:185], off nt
  s_mov_b64 exec, -1
  s_addk_i32 m0, 0x400
  v_lshl_add_u64 v[184:185], v[184:185], 0, s[14:15]
  s_waitcnt vmcnt(4)
  s_mov_b32 exec_lo, 0x0fffffff
  s_mov_b32 exec_hi, 0x0fffffff
  global_load_lds_dwordx4 v[184:185], off nt
  s_mov_b64 exec, -1
  s_addk_i32 m0, 0x400
  v_lshl_add_u64 v[184:185], v[184:185], 0, s[14:15]
  s_waitcnt vmcnt(4)
  s_mov_b32 exec_lo, 0x0fffffff
  s_mov_b32 exec_hi, 0x0fffffff
  global_load_lds_dwordx4 v[184:185], off nt
  s_mov_b64 exec, -1
  s_addk_i32 m0, 0x400
  v_lshl_add_u64 v[184:185], v[184:185], 0, s[14:15]
  s_waitcnt vmcnt(4)
  s_mov_b32 exec_lo, 0x0fffffff
  s_mov_b32 exec_hi, 0x0fffffff
  global_load_lds_dwordx4 v[184:185], off nt
  s_mov_b64 exec, -1
  s_lshl_b32 s31, s33, 11
  s_add_u32 m0, s31, 75776
  s_waitcnt vmcnt(4)
  global_load_lds_dwordx4 v190, s[20:21] offset:0 nt
  v_mov_b32 v192, 1
  s_mov_b64 s[38:39], exec
  s_mov_b64 exec, 1
  ds_add_u32 v204, v192 offset:41092
  s_mov_b64 exec, s[38:39]
  s_waitcnt vmcnt(4)
  v_mov_b32 v192, 1
  s_mov_b64 s[38:39], exec
  s_mov_b64 exec, 1
  ds_add_u32 v204, v192 offset:41096
  s_mov_b64 exec, s[38:39]
  global_load_lds_dwordx4 v190, s[20:21] offset:1024 nt
  s_mov_b32 s58, 512000
L_vwait_1:
  ds_read_b32 v192, v204 offset:41092
  s_sub_u32 s58, s58, 1
  s_cbranch_scc1 L_exit
  s_waitcnt lgkmcnt(0)
  v_cmp_gt_u32 vcc, 4, v192
  s_cbranch_vccnz L_vwait_1
  ds_read_b64_tr_b16 v[80:81], v206 offset:0
  ds_read_b64_tr_b16 v[82:83], v206 offset:4096
  ds_read_b64_tr_b16 v[84:85], v207 offset:0
  ds_read_b64_tr_b16 v[86:87], v207 offset:4096
  ds_read_b64_tr_b16 v[88:89], v206 offset:8192
  ds_read_b64_tr_b16 v[90:91], v206 offset:12288
  ds_read_b64_tr_b16 v[92:93], v207 offset:8192
  ds_read_b64_tr_b16 v[94:95], v207 offset:12288
  s_waitcnt lgkmcnt(4)
  ds_read_b64_tr_b16 v[96:97], v206 offset:16384
  ds_read_b64_tr_b16 v[98:99], v206 offset:20480
  ds_read_b64_tr_b16 v[100:101], v207 offset:16384
  ds_read_b64_tr_b16 v[102:103], v207 offset:20480
  ds_read_b64_tr_b16 v[104:105], v206 offset:24576
  ds_read_b64_tr_b16 v[106:107], v206 offset:28672
  ds_read_b64_tr_b16 v[108:109], v207 offset:24576
  ds_read_b64_tr_b16 v[110:111], v207 offset:28672
  s_branch L_S2
L_C:
  s_mov_b64 exec, -1
  s_lshr_b32 s29, s2, 3
  s_waitcnt lgkmcnt(0)
  s_load_dword s56, s[26:27], 0
  s_mul_i32 s59, s28, 196608
  s_add_u32 s59, s59, 1048576
  v_and_b32 v31, 7, v0
  s_lshl_b32 s35, s29, 5
  v_lshl_add_u32 v254, v31, 2, s35
  v_lshlrev_b32 v8, 4, v0
  s_lshr_b32 s30, s29, 1
  s_mul_i32 s3, s30, 6144
  s_and_b32 s30, s29, 1
  s_lshl_b32 s30, s30, 5
  s_add_u32 s34, s3, s30
  v_lshrrev_b32 v22, 1, v0
  v_lshl_add_u32 v15, v22, 6, s34
  v_and_b32 v26, 1, v0
  v_lshl_add_u32 v15, v26, 4, v15
  v_mov_b64 v[72:73], -1
  v_mov_b64 v[74:75], -1
  s_and_b32 s31, s29, 3
  s_lshl_b32 s31, s31, 5
  s_lshr_b32 s32, s29, 2
  s_lshl2_add_u32 s60, s32, s31
  v_lshl_add_u32 v27, v31, 7, s60
  v_cmp_gt_u32 vcc, 40, v0
  v_lshrrev_b32 v78, 3, v0
  v_lshlrev_b32 v78, 10, v78
  v_cndmask_b32 v27, v27, v254, vcc
  v_add_u32 v78, v78, v27
  s_add_u32 s46, s26, s59
  s_addc_u32 s47, s27, 0
  s_add_u32 s36, s46, 2048
  s_addc_u32 s37, s47, 0
  s_add_u32 s40, s46, 6144
  s_addc_u32 s41, s47, 0
  s_add_u32 s46, s46, 167936
  s_addc_u32 s47, s47, 0
  s_cmp_eq_u32 s33, 4
  s_cbranch_scc0 L_Ypre
  global_load_dword v252, v254, s[4:5]
  s_mov_b32 exec_hi, 0x00ffffff
  global_store_dword v78, v72, s[46:47] offset:-4096
  s_mov_b64 exec, -1
  global_store_dwordx4 v15, v[72:75], s[36:37] offset:-2048
  s_mul_i32 s30, s30, 96
  s_add_u32 s30, s30, s3
  v_lshl_add_u32 v29, v0, 7, s30
  s_mov_b64 exec, 0xffffff
  global_load_dword v211, v29, s[36:37] offset:-2048 sc1
  s_lshl_b32 s30, s29, 8
  v_lshl_add_u32 v29, v0, 7, s30
  s_mov_b64 exec, 3
  global_load_dword v211, v29, s[46:47] offset:-4096 sc1
  s_mov_b64 exec, -1
  s_branch L_Cjoin
L_Ypre:
  global_load_dword v211, v254, s[22:23]
L_Cjoin:
  s_mov_b32 s62, 0x05040100
  s_mov_b32 s63, 0x07060302
  s_mov_b32 s64, 0x3f803f80
  s_add_u32 s48, s26, 65536
  s_addc_u32 s49, s27, 0
  s_add_u32 s50, s26, 131072
  s_addc_u32 s51, s27, 0
  s_add_u32 s52, s26, 196608
  s_addc_u32 s53, s27, 0
  s_add_u32 s54, s26, 262144
  s_addc_u32 s55, s27, 0
  v_mov_b64 v[214:215], 0
  v_mov_b64 v[216:217], 0
  v_mov_b64 v[218:219], 0
  v_mov_b64 v[220:221], 0
  s_getreg_b32 s61, hwreg(HW_REG_XCC_ID, 0, 4)
  v_mov_b64 v[76:77], 0
  v_and_b32 v20, 15, v0
  v_lshrrev_b32 v21, 4, v0
  v_lshrrev_b32 v23, 2, v20
  v_and_b32 v24, 3, v0
  v_lshrrev_b32 v7, 1, v20
  v_lshl_add_u32 v7, v7, 2, s35
  v_lshl_add_u32 v22, v21, 6, s34
  v_lshl_add_u32 v2, v20, 1, v22
  v_lshl_add_u32 v209, v24, 2, v22
  v_bfe_u32 v22, v0, 2, 1
  v_lshl_add_u32 v209, v22, 11, v209
  v_bfe_u32 v22, v0, 3, 1
  v_lshl_add_u32 v209, v22, 4, v209
  v_mov_b32 v1, 0xff
  s_lshr_b32 s31, s29, 3
  s_lshl_b32 s31, s31, 14
  s_and_b32 s32, s29, 7
  s_lshl_b32 s32, s32, 10
  s_add_u32 s31, s31, s32
  v_lshrrev_b32 v5, 3, v0
  v_lshlrev_b32 v5, 7, v5
  v_and_b32 v25, 7, v0
  v_lshl_add_u32 v5, v25, 3, v5
  v_add_u32 v5, s31, v5
  s_lshl_b32 s32, s28, 7
  s_add_u32 s31, s31, s32
  v_lshl_add_u32 v6, v20, 2, s31
  v_and_b32 v26, 1, v21
  v_lshl_add_u32 v6, v26, 13, v6
  v_lshlrev_b32 v79, 2, v21
  v_sub_u32 v79, v0, v79
  v_and_b32 v79, 15, v79
  v_lshl_add_u32 v79, v21, 4, v79
  v_lshlrev_b32 v79, 4, v79
  v_lshrrev_b32 v22, 2, v0
  v_mul_u32_u24 v22, 6144, v22
  v_lshl_add_u32 v22, v24, 4, v22
  s_lshl_b32 s32, s29, 6
  v_add_u32 v3, s32, v22
  s_sub_u32 s31, s33, 4
  s_mul_i32 s31, s31, 49152
  s_add_u32 s31, s31, s32
  v_lshrrev_b32 v22, 3, v0
  v_mul_u32_u24 v22, 6144, v22
  v_lshl_add_u32 v22, v31, 3, v22
  v_add_u32 v4, s31, v22
  s_lshr_b32 s32, s29, 3
  s_lshl_b32 s32, s32, 8
  v_lshl_add_u32 v9, v21, 5, s32
  s_and_b32 s31, s29, 3
  s_lshl_b32 s31, s31, 5
  s_lshr_b32 s32, s29, 2
  s_lshl_b32 s32, s32, 2
  s_add_u32 s31, s31, s32
  v_and_b32 v26, 1, v0
  v_and_b32 v27, 3, v23
  v_lshlrev_b32 v10, 8, v21
  v_lshl_add_u32 v10, v26, 7, v10
  v_add_u32 v10, s31, v10
  s_sub_u32 s31, s33, 4
  s_lshl_b32 s31, s31, 10
  s_add_u32 s31, s31, 32768
  v_add_u32 v11, s31, v8
  v_lshlrev_b32 v12, 4, v21
  v_add_u32 v12, 40960, v12
  s_mov_b32 s66, 0xaaaaaaaa
  s_mov_b32 s67, 0xaaaaaaaa
  s_mov_b32 s14, -1
  s_mov_b32 s15, 0x00ffffff
  s_lshr_b32 s31, s29, 1
  s_lshl_b32 s31, s31, 5
  s_and_b32 s32, s29, 1
  s_add_u32 s31, s32, s31
  s_bfe_u32 s32, s29, 0x30001
  s_lshl1_add_u32 s31, s32, s31
  s_lshl_b32 s32, s28, 9
  s_add_u32 s31, s31, s32
  s_lshl_b32 s31, s31, 10
  v_add_u32 v208, s31, v8
  v_and_b32 v253, 31, v0
  v_lshlrev_b32 v253, 2, v253
  s_cmp_eq_u32 s33, 4
  s_cbranch_scc0 L_Y
  v_mov_b64 v[40:41], 0
  v_mov_b64 v[42:43], 0
  v_mov_b64 v[44:45], 0
  v_mov_b64 v[46:47], 0
  v_add_u32 v64, 43008, v8
  s_waitcnt lgkmcnt(0)
  s_barrier
  s_add_u32 s57, s56, 1
  s_and_b32 s57, s57, 0x3f
  s_or_b32 s57, s57, 0x40
  ds_read_b128 v[80:83], v64 offset:0
  ds_read_b128 v[84:87], v64 offset:1024
  ds_read_b128 v[88:91], v64 offset:2048
  ds_read_b128 v[92:95], v64 offset:3072
  ds_read_b128 v[96:99], v64 offset:4096
  ds_read_b128 v[100:103], v64 offset:5120
  ds_read_b128 v[104:107], v64 offset:6144
  ds_read_b128 v[108:111], v64 offset:7168
  ds_read_b128 v[112:115], v64 offset:8192
  ds_read_b128 v[116:119], v64 offset:9216
  s_waitcnt lgkmcnt(8)
  v_perm_b32 v212, v84, v80, s62
  v_perm_b32 v84, v84, v80, s63
  v_perm_b32 v80, v85, v81, s62
  v_perm_b32 v85, v85, v81, s63
  v_perm_b32 v81, v86, v82, s62
  v_perm_b32 v86, v86, v82, s63
  v_perm_b32 v82, v87, v83, s62
  v_perm_b32 v87, v87, v83, s63
  ds_read_b128 v[120:123], v64 offset:10240
  ds_read_b128 v[124:127], v64 offset:11264
  s_waitcnt lgkmcnt(8)
  v_perm_b32 v83, v92, v88, s62
  v_perm_b32 v92, v92, v88, s63
  v_perm_b32 v88, v93, v89, s62
  v_perm_b32 v93, v93, v89, s63
  v_perm_b32 v89, v94, v90, s62
  v_perm_b32 v94, v94, v90, s63
  v_perm_b32 v90, v95, v91, s62
  v_perm_b32 v95, v95, v91, s63
  ds_read_b128 v[128:131], v64 offset:12288
  ds_read_b128 v[132:135], v64 offset:13312
  s_waitcnt lgkmcnt(8)
  v_perm_b32 v91, v100, v96, s62
  v_perm_b32 v100, v100, v96, s63
  v_perm_b32 v96, v101, v97, s62
  v_perm_b32 v101, v101, v97, s63
  v_perm_b32 v97, v102, v98, s62
  v_perm_b32 v102, v102, v98, s63
  v_perm_b32 v98, v103, v99, s62
  v_perm_b32 v103, v103, v99, s63
  ds_read_b128 v[136:139], v64 offset:14336
  ds_read_b128 v[140:143], v64 offset:15360
  s_waitcnt lgkmcnt(8)
  v_perm_b32 v99, v108, v104, s62
  v_perm_b32 v108, v108, v104, s63
  v_perm_b32 v104, v109, v105, s62
  v_perm_b32 v109, v109, v105, s63
  v_perm_b32 v105, v110, v106, s62
  v_perm_b32 v110, v110, v106, s63
  v_perm_b32 v106, v111, v107, s62
  v_perm_b32 v111, v111, v107, s63
  s_waitcnt lgkmcnt(6)
  v_perm_b32 v107, v116, v112, s62
  v_perm_b32 v116, v116, v112, s63
  v_perm_b32 v112, v117, v113, s62
  v_perm_b32 v117, v117, v113, s63
  v_perm_b32 v113, v118, v114, s62
  v_perm_b32 v118, v118, v114, s63
  v_perm_b32 v114, v119, v115, s62
  v_perm_b32 v119, v119, v115, s63
  s_waitcnt lgkmcnt(4)
  v_perm_b32 v115, v124, v120, s62
  v_perm_b32 v124, v124, v120, s63
  v_perm_b32 v120, v125, v121, s62
  v_perm_b32 v125, v125, v121, s63
  v_perm_b32 v121, v126, v122, s62
  v_perm_b32 v126, v126, v122, s63
  v_perm_b32 v122, v127, v123, s62
  v_perm_b32 v127, v127, v123, s63
  s_waitcnt lgkmcnt(2)
  v_perm_b32 v123, v132, v128, s62
  v_perm_b32 v132, v132, v128, s63
  v_perm_b32 v128, v133, v129, s62
  v_perm_b32 v133, v133, v129, s63
  v_perm_b32 v129, v134, v130, s62
  v_perm_b32 v134, v134, v130, s63
  v_perm_b32 v130, v135, v131, s62
  v_perm_b32 v135, v135, v131, s63
  s_waitcnt lgkmcnt(0)
  v_perm_b32 v131, v140, v136, s62
  v_perm_b32 v140, v140, v136, s63
  v_perm_b32 v136, v141, v137, s62
  v_perm_b32 v141, v141, v137, s63
  v_perm_b32 v137, v142, v138, s62
  v_perm_b32 v142, v142, v138, s63
  v_perm_b32 v138, v143, v139, s62
  v_perm_b32 v143, v143, v139, s63
  s_waitcnt vmcnt(5)
  v_mov_b64 v[52:53], 0
  v_mov_b32 v54, 0x3b000000
  v_mov_b32 v55, 0x3727c5ac
  v_dot2c_f32_bf16 v52, s64, v32
  v_dot2c_f32_bf16 v53, v32, v32
  v_dot2c_f32_bf16 v52, s64, v33
  v_dot2c_f32_bf16 v53, v33, v33
  v_dot2c_f32_bf16 v52, s64, v34
  v_dot2c_f32_bf16 v53, v34, v34
  v_dot2c_f32_bf16 v52, s64, v35
  v_dot2c_f32_bf16 v53, v35, v35
  s_nop 2
  v_permlane32_swap_b32 v52, v53
  v_add_f32 v52, v52, v53
  v_mov_b32 v53, v52
  s_nop 1
  v_permlane16_swap_b32 v52, v53
  v_add_f32 v52, v52, v53
  s_nop 1
  v_add_f32_dpp v52, v52, v52 row_ror:8 row_mask:0xf bank_mask:0xf
  s_nop 1
  v_add_f32_dpp v52, v52, v52 row_ror:4 row_mask:0xf bank_mask:0xf
  s_nop 1
  v_add_f32_dpp v52, v52, v52 row_ror:2 row_mask:0xf bank_mask:0xf
  s_nop 1
  v_add_f32_dpp v52, v52, v52 row_ror:1 row_mask:0xf bank_mask:0xf
  s_nop 0
  v_readlane_b32 s30, v52, 0
  v_readlane_b32 s31, v52, 32
  s_nop 0
  v_mul_f32 v17, s30, v54
  v_fma_f32 v18, s31, v54, v55
  v_fma_f32 v18, -v17, v17, v18
  v_max_f32 v18, v18, v55
  v_rsq_f32 v18, v18
  s_waitcnt vmcnt(4)
  v_lshlrev_b32 v13, 16, v252
  v_and_b32 v252, 0xffff0000, v252
  v_sub_f32 v20, v13, v17
  v_sub_f32 v21, v252, v17
  v_cvt_pk_bf16_f32 v16, v20, v21
  s_nop 1
  v_dot2c_f32_bf16_dpp v40, v16, v212 row_newbcast:0 row_mask:0xf bank_mask:0xf
  v_dot2c_f32_bf16_dpp v41, v16, v84 row_newbcast:0 row_mask:0xf bank_mask:0xf
  v_dot2c_f32_bf16_dpp v42, v16, v80 row_newbcast:0 row_mask:0xf bank_mask:0xf
  v_dot2c_f32_bf16_dpp v43, v16, v85 row_newbcast:0 row_mask:0xf bank_mask:0xf
  v_dot2c_f32_bf16_dpp v44, v16, v81 row_newbcast:0 row_mask:0xf bank_mask:0xf
  v_dot2c_f32_bf16_dpp v45, v16, v86 row_newbcast:0 row_mask:0xf bank_mask:0xf
  v_dot2c_f32_bf16_dpp v46, v16, v82 row_newbcast:0 row_mask:0xf bank_mask:0xf
  v_dot2c_f32_bf16_dpp v47, v16, v87 row_newbcast:0 row_mask:0xf bank_mask:0xf
  v_dot2c_f32_bf16_dpp v40, v16, v83 row_newbcast:1 row_mask:0xf bank_mask:0xf
  v_dot2c_f32_bf16_dpp v41, v16, v92 row_newbcast:1 row_mask:0xf bank_mask:0xf
  v_dot2c_f32_bf16_dpp v42, v16, v88 row_newbcast:1 row_mask:0xf bank_mask:0xf
  v_dot2c_f32_bf16_dpp v43, v16, v93 row_newbcast:1 row_mask:0xf bank_mask:0xf
  v_dot2c_f32_bf16_dpp v44, v16, v89 row_newbcast:1 row_mask:0xf bank_mask:0xf
  v_dot2c_f32_bf16_dpp v45, v16, v94 row_newbcast:1 row_mask:0xf bank_mask:0xf
  v_dot2c_f32_bf16_dpp v46, v16, v90 row_newbcast:1 row_mask:0xf bank_mask:0xf
  v_dot2c_f32_bf16_dpp v47, v16, v95 row_newbcast:1 row_mask:0xf bank_mask:0xf
  v_dot2c_f32_bf16_dpp v40, v16, v91 row_newbcast:2 row_mask:0xf bank_mask:0xf
  v_dot2c_f32_bf16_dpp v41, v16, v100 row_newbcast:2 row_mask:0xf bank_mask:0xf
  v_dot2c_f32_bf16_dpp v42, v16, v96 row_newbcast:2 row_mask:0xf bank_mask:0xf
  v_dot2c_f32_bf16_dpp v43, v16, v101 row_newbcast:2 row_mask:0xf bank_mask:0xf
  v_dot2c_f32_bf16_dpp v44, v16, v97 row_newbcast:2 row_mask:0xf bank_mask:0xf
  v_dot2c_f32_bf16_dpp v45, v16, v102 row_newbcast:2 row_mask:0xf bank_mask:0xf
  v_dot2c_f32_bf16_dpp v46, v16, v98 row_newbcast:2 row_mask:0xf bank_mask:0xf
  v_dot2c_f32_bf16_dpp v47, v16, v103 row_newbcast:2 row_mask:0xf bank_mask:0xf
  v_dot2c_f32_bf16_dpp v40, v16, v99 row_newbcast:3 row_mask:0xf bank_mask:0xf
  v_dot2c_f32_bf16_dpp v41, v16, v108 row_newbcast:3 row_mask:0xf bank_mask:0xf
  v_dot2c_f32_bf16_dpp v42, v16, v104 row_newbcast:3 row_mask:0xf bank_mask:0xf
  v_dot2c_f32_bf16_dpp v43, v16, v109 row_newbcast:3 row_mask:0xf bank_mask:0xf
  v_dot2c_f32_bf16_dpp v44, v16, v105 row_newbcast:3 row_mask:0xf bank_mask:0xf
  v_dot2c_f32_bf16_dpp v45, v16, v110 row_newbcast:3 row_mask:0xf bank_mask:0xf
  v_dot2c_f32_bf16_dpp v46, v16, v106 row_newbcast:3 row_mask:0xf bank_mask:0xf
  v_dot2c_f32_bf16_dpp v47, v16, v111 row_newbcast:3 row_mask:0xf bank_mask:0xf
  v_dot2c_f32_bf16_dpp v40, v16, v107 row_newbcast:4 row_mask:0xf bank_mask:0xf
  v_dot2c_f32_bf16_dpp v41, v16, v116 row_newbcast:4 row_mask:0xf bank_mask:0xf
  v_dot2c_f32_bf16_dpp v42, v16, v112 row_newbcast:4 row_mask:0xf bank_mask:0xf
  v_dot2c_f32_bf16_dpp v43, v16, v117 row_newbcast:4 row_mask:0xf bank_mask:0xf
  v_dot2c_f32_bf16_dpp v44, v16, v113 row_newbcast:4 row_mask:0xf bank_mask:0xf
  v_dot2c_f32_bf16_dpp v45, v16, v118 row_newbcast:4 row_mask:0xf bank_mask:0xf
  v_dot2c_f32_bf16_dpp v46, v16, v114 row_newbcast:4 row_mask:0xf bank_mask:0xf
  v_dot2c_f32_bf16_dpp v47, v16, v119 row_newbcast:4 row_mask:0xf bank_mask:0xf
  v_dot2c_f32_bf16_dpp v40, v16, v115 row_newbcast:5 row_mask:0xf bank_mask:0xf
  v_dot2c_f32_bf16_dpp v41, v16, v124 row_newbcast:5 row_mask:0xf bank_mask:0xf
  v_dot2c_f32_bf16_dpp v42, v16, v120 row_newbcast:5 row_mask:0xf bank_mask:0xf
  v_dot2c_f32_bf16_dpp v43, v16, v125 row_newbcast:5 row_mask:0xf bank_mask:0xf
  v_dot2c_f32_bf16_dpp v44, v16, v121 row_newbcast:5 row_mask:0xf bank_mask:0xf
  v_dot2c_f32_bf16_dpp v45, v16, v126 row_newbcast:5 row_mask:0xf bank_mask:0xf
  v_dot2c_f32_bf16_dpp v46, v16, v122 row_newbcast:5 row_mask:0xf bank_mask:0xf
  v_dot2c_f32_bf16_dpp v47, v16, v127 row_newbcast:5 row_mask:0xf bank_mask:0xf
  v_dot2c_f32_bf16_dpp v40, v16, v123 row_newbcast:6 row_mask:0xf bank_mask:0xf
  v_dot2c_f32_bf16_dpp v41, v16, v132 row_newbcast:6 row_mask:0xf bank_mask:0xf
  v_dot2c_f32_bf16_dpp v42, v16, v128 row_newbcast:6 row_mask:0xf bank_mask:0xf
  v_dot2c_f32_bf16_dpp v43, v16, v133 row_newbcast:6 row_mask:0xf bank_mask:0xf
  v_dot2c_f32_bf16_dpp v44, v16, v129 row_newbcast:6 row_mask:0xf bank_mask:0xf
  v_dot2c_f32_bf16_dpp v45, v16, v134 row_newbcast:6 row_mask:0xf bank_mask:0xf
  v_dot2c_f32_bf16_dpp v46, v16, v130 row_newbcast:6 row_mask:0xf bank_mask:0xf
  v_dot2c_f32_bf16_dpp v47, v16, v135 row_newbcast:6 row_mask:0xf bank_mask:0xf
  v_dot2c_f32_bf16_dpp v40, v16, v131 row_newbcast:7 row_mask:0xf bank_mask:0xf
  v_dot2c_f32_bf16_dpp v41, v16, v140 row_newbcast:7 row_mask:0xf bank_mask:0xf
  v_dot2c_f32_bf16_dpp v42, v16, v136 row_newbcast:7 row_mask:0xf bank_mask:0xf
  v_dot2c_f32_bf16_dpp v43, v16, v141 row_newbcast:7 row_mask:0xf bank_mask:0xf
  v_dot2c_f32_bf16_dpp v44, v16, v137 row_newbcast:7 row_mask:0xf bank_mask:0xf
  v_dot2c_f32_bf16_dpp v45, v16, v142 row_newbcast:7 row_mask:0xf bank_mask:0xf
  v_dot2c_f32_bf16_dpp v46, v16, v138 row_newbcast:7 row_mask:0xf bank_mask:0xf
  v_dot2c_f32_bf16_dpp v47, v16, v143 row_newbcast:7 row_mask:0xf bank_mask:0xf
  s_waitcnt vmcnt(2)
  s_setprio 0
  v_bfi_b32 v40, v1, s57, v40
  v_bfi_b32 v41, v1, s57, v41
  v_bfi_b32 v42, v1, s57, v42
  v_bfi_b32 v43, v1, s57, v43
  v_bfi_b32 v44, v1, s57, v44
  v_bfi_b32 v45, v1, s57, v45
  v_bfi_b32 v46, v1, s57, v46
  v_bfi_b32 v47, v1, s57, v47
  global_store_dwordx4 v3, v[40:43], s[36:37] offset:0
  global_store_dwordx4 v3, v[44:47], s[36:37] offset:2048
  s_add_u32 s3, s56, 1
  s_lshl_b32 s3, s3, 4
  s_add_u32 s32, s3, 16
  s_or_b32 s3, s3, s61
  s_add_u32 s24, s3, 16
  v_mov_b32 v48, s3
  s_lshl_b32 s31, s29, 2
  v_mov_b32 v49, s31
  s_mov_b64 exec, 1
  global_store_dword v49, v48, s[46:47] offset:3072
  s_mov_b64 exec, -1
  v_mov_b64 v[40:41], 0
  v_mov_b64 v[42:43], 0
  v_mov_b64 v[44:45], 0
  v_mov_b64 v[46:47], 0
  v_dot2c_f32_bf16 v40, s64, v212
  v_dot2c_f32_bf16 v41, s64, v84
  v_dot2c_f32_bf16 v42, s64, v80
  v_dot2c_f32_bf16 v43, s64, v85
  v_dot2c_f32_bf16 v44, s64, v81
  v_dot2c_f32_bf16 v45, s64, v86
  v_dot2c_f32_bf16 v46, s64, v82
  v_dot2c_f32_bf16 v47, s64, v87
  v_dot2c_f32_bf16 v40, s64, v83
  v_dot2c_f32_bf16 v41, s64, v92
  v_dot2c_f32_bf16 v42, s64, v88
  v_dot2c_f32_bf16 v43, s64, v93
  v_dot2c_f32_bf16 v44, s64, v89
  v_dot2c_f32_bf16 v45, s64, v94
  v_dot2c_f32_bf16 v46, s64, v90
  v_dot2c_f32_bf16 v47, s64, v95
  v_dot2c_f32_bf16 v40, s64, v91
  v_dot2c_f32_bf16 v41, s64, v100
  v_dot2c_f32_bf16 v42, s64, v96
  v_dot2c_f32_bf16 v43, s64, v101
  v_dot2c_f32_bf16 v44, s64, v97
  v_dot2c_f32_bf16 v45, s64, v102
  v_dot2c_f32_bf16 v46, s64, v98
  v_dot2c_f32_bf16 v47, s64, v103
  v_dot2c_f32_bf16 v40, s64, v99
  v_dot2c_f32_bf16 v41, s64, v108
  v_dot2c_f32_bf16 v42, s64, v104
  v_dot2c_f32_bf16 v43, s64, v109
  v_dot2c_f32_bf16 v44, s64, v105
  v_dot2c_f32_bf16 v45, s64, v110
  v_dot2c_f32_bf16 v46, s64, v106
  v_dot2c_f32_bf16 v47, s64, v111
  v_dot2c_f32_bf16 v40, s64, v107
  v_dot2c_f32_bf16 v41, s64, v116
  v_dot2c_f32_bf16 v42, s64, v112
  v_dot2c_f32_bf16 v43, s64, v117
  v_dot2c_f32_bf16 v44, s64, v113
  v_dot2c_f32_bf16 v45, s64, v118
  v_dot2c_f32_bf16 v46, s64, v114
  v_dot2c_f32_bf16 v47, s64, v119
  v_dot2c_f32_bf16 v40, s64, v115
  v_dot2c_f32_bf16 v41, s64, v124
  v_dot2c_f32_bf16 v42, s64, v120
  v_dot2c_f32_bf16 v43, s64, v125
  v_dot2c_f32_bf16 v44, s64, v121
  v_dot2c_f32_bf16 v45, s64, v126
  v_dot2c_f32_bf16 v46, s64, v122
  v_dot2c_f32_bf16 v47, s64, v127
  v_dot2c_f32_bf16 v40, s64, v123
  v_dot2c_f32_bf16 v41, s64, v132
  v_dot2c_f32_bf16 v42, s64, v128
  v_dot2c_f32_bf16 v43, s64, v133
  v_dot2c_f32_bf16 v44, s64, v129
  v_dot2c_f32_bf16 v45, s64, v134
  v_dot2c_f32_bf16 v46, s64, v130
  v_dot2c_f32_bf16 v47, s64, v135
  v_dot2c_f32_bf16 v40, s64, v131
  v_dot2c_f32_bf16 v41, s64, v140
  v_dot2c_f32_bf16 v42, s64, v136
  v_dot2c_f32_bf16 v43, s64, v141
  v_dot2c_f32_bf16 v44, s64, v137
  v_dot2c_f32_bf16 v45, s64, v142
  v_dot2c_f32_bf16 v46, s64, v138
  v_dot2c_f32_bf16 v47, s64, v143
  v_cvt_pk_bf16_f32 v242, v40, v41
  v_cvt_pk_bf16_f32 v243, v42, v43
  v_cvt_pk_bf16_f32 v244, v44, v45
  v_cvt_pk_bf16_f32 v245, v46, v47
  s_mov_b32 s58, 64
  s_sleep 3
  global_load_dword v222, v209, s[36:37] offset:0 sc1
  global_load_dword v223, v209, s[36:37] offset:256 sc1
  global_load_dword v224, v209, s[36:37] offset:512 sc1
  global_load_dword v225, v209, s[36:37] offset:768 sc1
  global_load_dword v226, v209, s[36:37] offset:1024 sc1
  global_load_dword v227, v209, s[36:37] offset:1280 sc1
  global_load_dword v228, v209, s[36:37] offset:1536 sc1
  global_load_dword v229, v209, s[36:37] offset:1792 sc1
  global_load_dword v238, v253, s[46:47] offset:3072 sc1
  s_sleep 7
  global_load_dword v222, v209, s[36:37] offset:0 sc1
  global_load_dword v223, v209, s[36:37] offset:256 sc1
  global_load_dword v224, v209, s[36:37] offset:512 sc1
  global_load_dword v225, v209, s[36:37] offset:768 sc1
  global_load_dword v226, v209, s[36:37] offset:1024 sc1
  global_load_dword v227, v209, s[36:37] offset:1280 sc1
  global_load_dword v228, v209, s[36:37] offset:1536 sc1
  global_load_dword v229, v209, s[36:37] offset:1792 sc1
  global_load_dword v238, v253, s[46:47] offset:3072 sc1
  s_sleep 7
L_q0_2:
  global_load_dword v222, v209, s[36:37] offset:0 sc1
  global_load_dword v223, v209, s[36:37] offset:256 sc1
  global_load_dword v224, v209, s[36:37] offset:512 sc1
  global_load_dword v225, v209, s[36:37] offset:768 sc1
  global_load_dword v226, v209, s[36:37] offset:1024 sc1
  global_load_dword v227, v209, s[36:37] offset:1280 sc1
  global_load_dword v228, v209, s[36:37] offset:1536 sc1
  global_load_dword v229, v209, s[36:37] offset:1792 sc1
  global_load_dword v238, v253, s[46:47] offset:3072 sc1
  s_sub_u32 s58, s58, 1
  s_cbranch_scc1 L_q0_over_3
  s_sleep 3
  s_waitcnt vmcnt(18)
  v_cmp_ne_u32 s[30:31], s3, v238
  v_xor_b32 v28, s57, v222
  v_xor_b32 v29, s57, v223
  v_xor_b32 v30, s57, v224
  v_xor_b32 v31, s57, v225
  v_xor_b32 v32, s57, v226
  v_xor_b32 v33, s57, v227
  v_xor_b32 v34, s57, v228
  v_xor_b32 v35, s57, v229
  v_or3_b32 v48, v28, v29, v30
  v_or3_b32 v48, v48, v31, v32
  v_or3_b32 v48, v48, v33, v34
  v_or_b32 v48, v48, v35
  v_cmp_ne_u32_sdwa vcc, v48, 0 src0_sel:BYTE_0 src1_sel:DWORD
  v_pk_add_f32 v[20:21], v[28:29], v[30:31]
  v_pk_add_f32 v[22:23], v[32:33], v[34:35]
  v_pk_add_f32 v[20:21], v[20:21], v[22:23]
  v_add_f32 v20, v20, v21
  s_or_b64 vcc, vcc, s[30:31]
  s_cbranch_vccnz L_q0_2
  v_mov_b32 v48, v20
  s_nop 1
  v_permlane32_swap_b32 v20, v48
  v_add_f32 v20, v20, v48
  v_mov_b32 v48, v20
  s_nop 1
  v_permlane16_swap_b32 v20, v48
  v_add_f32 v20, v20, v48
  v_mul_f32 v20, v20, v18
  s_nop 1
  v_mov_b32_dpp v48, v20 quad_perm:[1,0,3,2] row_mask:0xf bank_mask:0xf
  v_cvt_pk_bf16_f32 v16, v20, v48
  s_mov_b64 exec, 0x5555
  global_store_dword v7, v16, s[46:47] offset:-4096
  s_mov_b64 exec, -1
  global_store_dwordx4 v15, v[72:75], s[36:37] offset:0
  global_store_dwordx4 v15, v[72:75], s[36:37] offset:2048
  v_mov_b32 v49, 0
  ds_write_b32 v76, v49 offset:41088
  s_mov_b32 s58, 128000
  s_sleep 4
  global_load_dwordx4 v[238:241], v79, s[46:47] offset:-4096 sc1
  s_sleep 7
  global_load_dwordx4 v[238:241], v79, s[46:47] offset:-4096 sc1
  s_sleep 7
L_aq_4:
  global_load_dwordx4 v[238:241], v79, s[46:47] offset:-4096 sc1
  s_sub_u32 s58, s58, 1
  s_cbranch_scc1 L_exit
  s_sleep 3
  s_waitcnt vmcnt(2)
  v_max3_u32 v48, v238, v239, v240
  v_max_u32 v48, v48, v241
  v_cmp_eq_u32 vcc, -1, v48
  s_cbranch_vccnz L_aq_4
  ds_write_b128 v8, v[238:241] offset:41984
  s_waitcnt lgkmcnt(0)
  s_barrier
  v_mov_b64 v[222:223], 0
  v_mov_b64 v[224:225], 0
  v_mov_b64 v[226:227], 0
  v_mov_b64 v[228:229], 0
  v_lshrrev_b32 v48, 5, v0
  v_lshlrev_b32 v48, 16, v48
  v_add_u32 v48, v48, v6
  global_atomic_swap v48, v76, s[48:49]
  global_atomic_swap v48, v76, s[52:53]
  v_mov_b32 v68, s64
  v_mov_b32 v69, s64
  v_mov_b32 v70, s64
  v_mov_b32 v71, s64
  s_barrier
  ds_read_b128 v[48:51], v8 offset:32768
  ds_read_b128 v[52:55], v8 offset:33792
  ds_read_b128 v[56:59], v8 offset:34816
  ds_read_b128 v[60:63], v8 offset:35840
  ds_read_b128 v[64:67], v12
  s_waitcnt lgkmcnt(4)
  v_mfma_f32_16x16x32_bf16 v[20:23], v[48:51], v[68:71], 0
  s_waitcnt lgkmcnt(3)
  v_mfma_f32_16x16x32_bf16 v[20:23], v[52:55], v[68:71], v[20:23]
  s_waitcnt lgkmcnt(2)
  v_mfma_f32_16x16x32_bf16 v[20:23], v[56:59], v[68:71], v[20:23]
  s_waitcnt lgkmcnt(1)
  v_mfma_f32_16x16x32_bf16 v[20:23], v[60:63], v[68:71], v[20:23]
  s_waitcnt lgkmcnt(0)
  v_or3_b32 v28, v64, v65, v66
  v_or_b32 v28, v28, v67
  v_cmp_ne_u32 vcc, 0, v28
  s_cbranch_vccnz L_cgen_6
  s_mov_b32 exec_lo, 0x00020002
  s_mov_b32 exec_hi, 0x00020002
L_cback_7:
  s_nop 0
  global_store_dword v10, v20, s[46:47] offset:1024
  s_mov_b64 exec, -1
  s_barrier
  v_lshrrev_b32 v64, 1, v0
  v_lshlrev_b32 v64, 4, v64
  v_and_b32 v65, 1, v0
  v_lshl_add_u32 v64, v65, 9, v64
  v_add_u32 v64, 59392, v64
  s_mov_b32 s65, 512000
  v_mov_b64 v[40:41], 0
  v_mov_b64 v[42:43], 0
  v_mov_b64 v[44:45], 0
  v_mov_b64 v[46:47], 0
L_cnt_8:
  ds_read_b32 v49, v76 offset:41100
  s_sub_u32 s65, s65, 1
  s_cbranch_scc1 L_exit
  s_waitcnt lgkmcnt(0)
  v_cmp_gt_u32 vcc, 4, v49
  s_cbranch_vccnz L_cnt_8
  ds_read_b128 v[144:147], v64 offset:0
  ds_read_b128 v[148:151], v64 offset:1024
  ds_read_b128 v[152:155], v64 offset:2048
  ds_read_b128 v[156:159], v64 offset:3072
  ds_read_b128 v[160:163], v64 offset:4096
  ds_read_b128 v[164:167], v64 offset:5120
  ds_read_b128 v[168:171], v64 offset:6144
  ds_read_b128 v[172:175], v64 offset:7168
  ds_read_b128 v[176:179], v64 offset:8192
  ds_read_b128 v[180:183], v64 offset:9216
  s_waitcnt lgkmcnt(8)
  v_perm_b32 v139, v148, v144, s62
  v_perm_b32 v148, v148, v144, s63
  v_perm_b32 v144, v149, v145, s62
  v_perm_b32 v149, v149, v145, s63
  v_perm_b32 v145, v150, v146, s62
  v_perm_b32 v150, v150, v146, s63
  v_perm_b32 v146, v151, v147, s62
  v_perm_b32 v151, v151, v147, s63
  v_dot2c_f32_bf16 v40, s64, v139
  v_dot2c_f32_bf16 v41, s64, v148
  v_dot2c_f32_bf16 v42, s64, v144
  v_dot2c_f32_bf16 v43, s64, v149
  v_dot2c_f32_bf16 v44, s64, v145
  v_dot2c_f32_bf16 v45, s64, v150
  v_dot2c_f32_bf16 v46, s64, v146
  v_dot2c_f32_bf16 v47, s64, v151
  ds_read_b128 v[184:187], v64 offset:10240
  ds_read_b128 v[188:191], v64 offset:11264
  s_waitcnt lgkmcnt(8)
  v_perm_b32 v147, v156, v152, s62
  v_perm_b32 v156, v156, v152, s63
  v_perm_b32 v152, v157, v153, s62
  v_perm_b32 v157, v157, v153, s63
  v_perm_b32 v153, v158, v154, s62
  v_perm_b32 v158, v158, v154, s63
  v_perm_b32 v154, v159, v155, s62
  v_perm_b32 v159, v159, v155, s63
  v_dot2c_f32_bf16 v40, s64, v147
  v_dot2c_f32_bf16 v41, s64, v156
  v_dot2c_f32_bf16 v42, s64, v152
  v_dot2c_f32_bf16 v43, s64, v157
  v_dot2c_f32_bf16 v44, s64, v153
  v_dot2c_f32_bf16 v45, s64, v158
  v_dot2c_f32_bf16 v46, s64, v154
  v_dot2c_f32_bf16 v47, s64, v159
  ds_read_b128 v[192:195], v64 offset:12288
  ds_read_b128 v[196:199], v64 offset:13312
  s_waitcnt lgkmcnt(8)
  v_perm_b32 v155, v164, v160, s62
  v_perm_b32 v164, v164, v160, s63
  v_perm_b32 v160, v165, v161, s62
  v_perm_b32 v165, v165, v161, s63
  v_perm_b32 v161, v166, v162, s62
  v_perm_b32 v166, v166, v162, s63
  v_perm_b32 v162, v167, v163, s62
  v_perm_b32 v167, v167, v163, s63
  v_dot2c_f32_bf16 v40, s64, v155
  v_dot2c_f32_bf16 v41, s64, v164
  v_dot2c_f32_bf16 v42, s64, v160
  v_dot2c_f32_bf16 v43, s64, v165
  v_dot2c_f32_bf16 v44, s64, v161
  v_dot2c_f32_bf16 v45, s64, v166
  v_dot2c_f32_bf16 v46, s64, v162
  v_dot2c_f32_bf16 v47, s64, v167
  ds_read_b128 v[200:203], v64 offset:14336
  ds_read_b128 v[204:207], v64 offset:15360
  s_waitcnt lgkmcnt(8)
  v_perm_b32 v163, v172, v168, s62
  v_perm_b32 v172, v172, v168, s63
  v_perm_b32 v168, v173, v169, s62
  v_perm_b32 v173, v173, v169, s63
  v_perm_b32 v169, v174, v170, s62
  v_perm_b32 v174, v174, v170, s63
  v_perm_b32 v170, v175, v171, s62
  v_perm_b32 v175, v175, v171, s63
  v_dot2c_f32_bf16 v40, s64, v163
  v_dot2c_f32_bf16 v41, s64, v172
  v_dot2c_f32_bf16 v42, s64, v168
  v_dot2c_f32_bf16 v43, s64, v173
  v_dot2c_f32_bf16 v44, s64, v169
  v_dot2c_f32_bf16 v45, s64, v174
  v_dot2c_f32_bf16 v46, s64, v170
  v_dot2c_f32_bf16 v47, s64, v175
  s_waitcnt lgkmcnt(6)
  v_perm_b32 v171, v180, v176, s62
  v_perm_b32 v180, v180, v176, s63
  v_perm_b32 v176, v181, v177, s62
  v_perm_b32 v181, v181, v177, s63
  v_perm_b32 v177, v182, v178, s62
  v_perm_b32 v182, v182, v178, s63
  v_perm_b32 v178, v183, v179, s62
  v_perm_b32 v183, v183, v179, s63
  v_dot2c_f32_bf16 v40, s64, v171
  v_dot2c_f32_bf16 v41, s64, v180
  v_dot2c_f32_bf16 v42, s64, v176
  v_dot2c_f32_bf16 v43, s64, v181
  v_dot2c_f32_bf16 v44, s64, v177
  v_dot2c_f32_bf16 v45, s64, v182
  v_dot2c_f32_bf16 v46, s64, v178
  v_dot2c_f32_bf16 v47, s64, v183
  s_waitcnt lgkmcnt(4)
  v_perm_b32 v179, v188, v184, s62
  v_perm_b32 v188, v188, v184, s63
  v_perm_b32 v184, v189, v185, s62
  v_perm_b32 v189, v189, v185, s63
  v_perm_b32 v185, v190, v186, s62
  v_perm_b32 v190, v190, v186, s63
  v_perm_b32 v186, v191, v187, s62
  v_perm_b32 v191, v191, v187, s63
  v_dot2c_f32_bf16 v40, s64, v179
  v_dot2c_f32_bf16 v41, s64, v188
  v_dot2c_f32_bf16 v42, s64, v184
  v_dot2c_f32_bf16 v43, s64, v189
  v_dot2c_f32_bf16 v44, s64, v185
  v_dot2c_f32_bf16 v45, s64, v190
  v_dot2c_f32_bf16 v46, s64, v186
  v_dot2c_f32_bf16 v47, s64, v191
  s_waitcnt lgkmcnt(2)
  v_perm_b32 v187, v196, v192, s62
  v_perm_b32 v196, v196, v192, s63
  v_perm_b32 v192, v197, v193, s62
  v_perm_b32 v197, v197, v193, s63
  v_perm_b32 v193, v198, v194, s62
  v_perm_b32 v198, v198, v194, s63
  v_perm_b32 v194, v199, v195, s62
  v_perm_b32 v199, v199, v195, s63
  v_dot2c_f32_bf16 v40, s64, v187
  v_dot2c_f32_bf16 v41, s64, v196
  v_dot2c_f32_bf16 v42, s64, v192
  v_dot2c_f32_bf16 v43, s64, v197
  v_dot2c_f32_bf16 v44, s64, v193
  v_dot2c_f32_bf16 v45, s64, v198
  v_dot2c_f32_bf16 v46, s64, v194
  v_dot2c_f32_bf16 v47, s64, v199
  s_waitcnt lgkmcnt(0)
  v_perm_b32 v195, v204, v200, s62
  v_perm_b32 v204, v204, v200, s63
  v_perm_b32 v200, v205, v201, s62
  v_perm_b32 v205, v205, v201, s63
  v_perm_b32 v201, v206, v202, s62
  v_perm_b32 v206, v206, v202, s63
  v_perm_b32 v202, v207, v203, s62
  v_perm_b32 v207, v207, v203, s63
  v_dot2c_f32_bf16 v40, s64, v195
  v_dot2c_f32_bf16 v41, s64, v204
  v_dot2c_f32_bf16 v42, s64, v200
  v_dot2c_f32_bf16 v43, s64, v205
  v_dot2c_f32_bf16 v44, s64, v201
  v_dot2c_f32_bf16 v45, s64, v206
  v_dot2c_f32_bf16 v46, s64, v202
  v_dot2c_f32_bf16 v47, s64, v207
  v_cvt_pk_bf16_f32 v246, v40, v41
  v_cvt_pk_bf16_f32 v247, v42, v43
  v_cvt_pk_bf16_f32 v248, v44, v45
  v_cvt_pk_bf16_f32 v249, v46, v47
  v_mov_b64 v[40:41], 0
  v_mov_b64 v[42:43], 0
  v_mov_b64 v[44:45], 0
  v_mov_b64 v[46:47], 0
  s_add_u32 s57, s56, 11
  s_and_b32 s57, s57, 0x3f
  s_or_b32 s57, s57, 0x40
  s_barrier
  s_mov_b64 exec, s[14:15]
  global_store_dwordx4 v3, v[246:249], s[36:37] offset:2048
  s_mov_b64 exec, -1
  s_mov_b32 s65, 2000
  s_mov_b32 s58, 64
  s_nop 15
  s_nop 3
  global_load_short_d16_hi v214, v2, s[36:37] offset:0 sc1
  global_load_short_d16_hi v215, v2, s[36:37] offset:256 sc1
  global_load_short_d16_hi v216, v2, s[36:37] offset:512 sc1
  global_load_short_d16_hi v217, v2, s[36:37] offset:768 sc1
  global_load_short_d16_hi v218, v2, s[36:37] offset:1024 sc1
  global_load_short_d16_hi v219, v2, s[36:37] offset:1280 sc1
  global_load_short_d16_hi v220, v2, s[36:37] offset:1536 sc1
  global_load_short_d16_hi v221, v2, s[36:37] offset:1792 sc1
  s_nop 14
  global_load_short_d16_hi v214, v2, s[36:37] offset:0 sc1
  global_load_short_d16_hi v215, v2, s[36:37] offset:256 sc1
  global_load_short_d16_hi v216, v2, s[36:37] offset:512 sc1
  global_load_short_d16_hi v217, v2, s[36:37] offset:768 sc1
  global_load_short_d16_hi v218, v2, s[36:37] offset:1024 sc1
  global_load_short_d16_hi v219, v2, s[36:37] offset:1280 sc1
  global_load_short_d16_hi v220, v2, s[36:37] offset:1536 sc1
  global_load_short_d16_hi v221, v2, s[36:37] offset:1792 sc1
  s_nop 14
L_out_10:
  global_load_short_d16_hi v214, v2, s[36:37] offset:0 sc1
  global_load_short_d16_hi v215, v2, s[36:37] offset:256 sc1
  global_load_short_d16_hi v216, v2, s[36:37] offset:512 sc1
  global_load_short_d16_hi v217, v2, s[36:37] offset:768 sc1
  global_load_short_d16_hi v218, v2, s[36:37] offset:1024 sc1
  global_load_short_d16_hi v219, v2, s[36:37] offset:1280 sc1
  global_load_short_d16_hi v220, v2, s[36:37] offset:1536 sc1
  global_load_short_d16_hi v221, v2, s[36:37] offset:1792 sc1
  s_sub_u32 s58, s58, 1
  s_cbranch_scc1 L_out_over_11
  s_waitcnt vmcnt(20)
  v_pk_add_f32 v[20:21], v[214:215], v[216:217]
  s_waitcnt vmcnt(16)
  v_pk_add_f32 v[22:23], v[218:219], v[220:221]
  v_pk_add_f32 v[20:21], v[20:21], v[22:23]
  v_add_f32 v20, v20, v21
  v_mov_b32 v48, v20
  v_cmp_u_f32 vcc, v20, v20
  s_nop 0
  v_permlane32_swap_b32 v20, v48
  v_add_f32 v20, v20, v48
  v_mov_b32 v48, v20
  s_cbranch_vccnz L_out_10
L_out_done_9:
  s_nop 0
  v_permlane16_swap_b32 v20, v48
  v_add_f32 v20, v20, v48
  v_bfi_b32 v20, v1, s57, v20
  s_mov_b32 exec_hi, 0
  global_atomic_swap v6, v20, s[48:49]
  s_mov_b64 exec, -1
  global_store_dwordx4 v15, v[72:75], s[36:37] offset:0
  s_mov_b32 s58, 128000
  s_mov_b64 vcc, -1
  ds_read_b32 v48, v76 offset:41104
  s_lshr_b32 s30, s61, 2
  s_waitcnt lgkmcnt(0)
  v_readfirstlane_b32 s31, v48
  s_nop 1
  s_cmp_gt_i32 s31, 0
  s_cselect_b32 s31, 0, 1
  s_xor_b32 s30, s30, s31
  s_and_b32 s30, s30, 1
  s_lshl_b32 s30, s30, 13
  v_add_u32 v5, s30, v5
  global_atomic_or_x2 v[250:251], v5, v[76:77], s[48:49] sc0
  s_sleep 3
  global_atomic_or_x2 v[250:251], v5, v[76:77], s[48:49] sc0
  s_sleep 3
  global_atomic_or_x2 v[250:251], v5, v[76:77], s[48:49] sc0
  s_sleep 3
  global_atomic_or_x2 v[250:251], v5, v[76:77], s[48:49] sc0
L_g_13_c:
  s_waitcnt vmcnt(3)
  v_xor_b32 v20, s57, v250
  v_xor_b32 v21, s57, v251
  v_or_b32 v49, v20, v21
  v_cmp_ne_u32_sdwa vcc, v49, 0 src0_sel:BYTE_0 src1_sel:DWORD
  v_permlane32_swap_b32 v20, v21
  v_add_f32 v20, v20, v21
  v_mov_b32 v48, v20
  s_cbranch_vccnz L_g_13
  s_nop 0
  v_permlane16_swap_b32 v20, v48
  v_add_f32 v20, v20, v48
  s_nop 1
  v_add_f32_dpp v20, v20, v20 row_ror:8 row_mask:0xf bank_mask:0xf
  v_mov_b32 v21, v20
  s_nop 1
  v_permlane32_swap_b32 v20, v21
  v_add_f32 v20, v20, v13
  v_add_f32 v21, v21, v252
  v_cvt_pk_bf16_f32 v16, v20, v21
  s_mov_b64 exec, 0xff
  global_store_dword v254, v16, s[46:47] offset:-2048
  s_mov_b64 exec, -1
  s_barrier
  v_readlane_b32 s4, v16, 0
  v_readlane_b32 s5, v16, 1
  v_readlane_b32 s6, v16, 2
  v_dot2c_f32_bf16 v40, s4, v139
  v_dot2c_f32_bf16 v41, s4, v148
  v_readlane_b32 s7, v16, 3
  v_dot2c_f32_bf16 v42, s4, v144
  v_dot2c_f32_bf16 v43, s4, v149
  v_dot2c_f32_bf16 v44, s4, v145
  v_dot2c_f32_bf16 v45, s4, v150
  v_dot2c_f32_bf16 v46, s4, v146
  v_dot2c_f32_bf16 v47, s4, v151
  v_dot2c_f32_bf16 v40, s5, v147
  v_dot2c_f32_bf16 v41, s5, v156
  v_readlane_b32 s8, v16, 4
  v_dot2c_f32_bf16 v42, s5, v152
  v_dot2c_f32_bf16 v43, s5, v157
  v_dot2c_f32_bf16 v44, s5, v153
  v_dot2c_f32_bf16 v45, s5, v158
  v_dot2c_f32_bf16 v46, s5, v154
  v_dot2c_f32_bf16 v47, s5, v159
  v_dot2c_f32_bf16 v40, s6, v155
  v_dot2c_f32_bf16 v41, s6, v164
  v_readlane_b32 s9, v16, 5
  v_dot2c_f32_bf16 v42, s6, v160
  v_dot2c_f32_bf16 v43, s6, v165
  v_dot2c_f32_bf16 v44, s6, v161
  v_dot2c_f32_bf16 v45, s6, v166
  v_dot2c_f32_bf16 v46, s6, v162
  v_dot2c_f32_bf16 v47, s6, v167
  v_dot2c_f32_bf16 v40, s7, v163
  v_dot2c_f32_bf16 v41, s7, v172
  v_readlane_b32 s10, v16, 6
  v_dot2c_f32_bf16 v42, s7, v168
  v_dot2c_f32_bf16 v43, s7, v173
  v_dot2c_f32_bf16 v44, s7, v169
  v_dot2c_f32_bf16 v45, s7, v174
  v_dot2c_f32_bf16 v46, s7, v170
  v_dot2c_f32_bf16 v47, s7, v175
  v_dot2c_f32_bf16 v40, s8, v171
  v_dot2c_f32_bf16 v41, s8, v180
  v_readlane_b32 s11, v16, 7
  v_dot2c_f32_bf16 v42, s8, v176
  v_dot2c_f32_bf16 v43, s8, v181
  v_dot2c_f32_bf16 v44, s8, v177
  v_dot2c_f32_bf16 v45, s8, v182
  v_dot2c_f32_bf16 v46, s8, v178
  v_dot2c_f32_bf16 v47, s8, v183
  v_dot2c_f32_bf16 v40, s9, v179
  v_dot2c_f32_bf16 v41, s9, v188
  v_dot2c_f32_bf16 v42, s9, v184
  v_dot2c_f32_bf16 v43, s9, v189
  v_dot2c_f32_bf16 v44, s9, v185
  v_dot2c_f32_bf16 v45, s9, v190
  v_dot2c_f32_bf16 v46, s9, v186
  v_dot2c_f32_bf16 v47, s9, v191
  v_dot2c_f32_bf16 v40, s10, v187
  v_dot2c_f32_bf16 v41, s10, v196
  v_dot2c_f32_bf16 v42, s10, v192
  v_dot2c_f32_bf16 v43, s10, v197
  v_dot2c_f32_bf16 v44, s10, v193
  v_dot2c_f32_bf16 v45, s10, v198
  v_dot2c_f32_bf16 v46, s10, v194
  v_dot2c_f32_bf16 v47, s10, v199
  v_dot2c_f32_bf16 v40, s11, v195
  v_dot2c_f32_bf16 v41, s11, v204
  v_dot2c_f32_bf16 v42, s11, v200
  v_dot2c_f32_bf16 v43, s11, v205
  v_dot2c_f32_bf16 v44, s11, v201
  v_dot2c_f32_bf16 v45, s11, v206
  v_dot2c_f32_bf16 v46, s11, v202
  v_dot2c_f32_bf16 v47, s11, v207
  v_cvt_pk_bf16_f32 v48, v40, v41
  v_cvt_pk_bf16_f32 v49, v42, v43
  v_cvt_pk_bf16_f32 v50, v44, v45
  v_cvt_pk_bf16_f32 v51, v46, v47
  s_mov_b64 exec, s[14:15]
  global_store_dwordx4 v3, v[48:51], s[36:37] offset:-2048
  s_mov_b64 exec, -1
  v_lshlrev_b32 v13, 16, v16
  v_and_b32 v252, 0xffff0000, v16
  v_mov_b64 v[40:41], 0
  v_mov_b64 v[42:43], 0
  v_mov_b64 v[44:45], 0
  v_mov_b64 v[46:47], 0
  s_add_u32 s57, s56, 12
  s_and_b32 s57, s57, 0x3f
  s_or_b32 s57, s57, 0x40
  s_barrier
  s_mov_b32 s65, 2000
  s_mov_b32 s58, 64
  s_nop 15
  s_nop 3
  global_load_short_d16_hi v214, v2, s[36:37] offset:0 sc1
  global_load_short_d16_hi v215, v2, s[36:37] offset:256 sc1
  global_load_short_d16_hi v216, v2, s[36:37] offset:512 sc1
  global_load_short_d16_hi v217, v2, s[36:37] offset:768 sc1
  global_load_short_d16_hi v218, v2, s[36:37] offset:1024 sc1
  global_load_short_d16_hi v219, v2, s[36:37] offset:1280 sc1
  global_load_short_d16_hi v220, v2, s[36:37] offset:1536 sc1
  s_nop 14
  global_load_short_d16_hi v214, v2, s[36:37] offset:0 sc1
  global_load_short_d16_hi v215, v2, s[36:37] offset:256 sc1
  global_load_short_d16_hi v216, v2, s[36:37] offset:512 sc1
  global_load_short_d16_hi v217, v2, s[36:37] offset:768 sc1
  global_load_short_d16_hi v218, v2, s[36:37] offset:1024 sc1
  global_load_short_d16_hi v219, v2, s[36:37] offset:1280 sc1
  global_load_short_d16_hi v220, v2, s[36:37] offset:1536 sc1
  s_nop 14
L_out_15:
  global_load_short_d16_hi v214, v2, s[36:37] offset:0 sc1
  global_load_short_d16_hi v215, v2, s[36:37] offset:256 sc1
  global_load_short_d16_hi v216, v2, s[36:37] offset:512 sc1
  global_load_short_d16_hi v217, v2, s[36:37] offset:768 sc1
  global_load_short_d16_hi v218, v2, s[36:37] offset:1024 sc1
  global_load_short_d16_hi v219, v2, s[36:37] offset:1280 sc1
  global_load_short_d16_hi v220, v2, s[36:37] offset:1536 sc1
  s_sub_u32 s58, s58, 1
  s_cbranch_scc1 L_out_over_16
  s_waitcnt vmcnt(17)
  v_pk_add_f32 v[20:21], v[214:215], v[216:217]
  s_waitcnt vmcnt(14)
  v_pk_add_f32 v[20:21], v[20:21], v[218:219]
  v_add_f32 v20, v20, v220
  v_add_f32 v20, v20, v21
  v_mov_b32 v48, v20
  v_cmp_u_f32 vcc, v20, v20
  s_nop 0
  v_permlane32_swap_b32 v20, v48
  v_add_f32 v20, v20, v48
  v_mov_b32 v48, v20
  s_cbranch_vccnz L_out_15
L_out_done_14:
  s_nop 0
  v_permlane16_swap_b32 v20, v48
  v_add_f32 v20, v20, v48
  v_bfi_b32 v20, v1, s57, v20
  s_mov_b32 exec_hi, 0
  global_atomic_swap v6, v20, s[50:51]
  s_mov_b64 exec, -1
  global_store_dwordx4 v15, v[72:75], s[36:37] offset:0
  global_store_dwordx4 v3, v[242:245], s[36:37] offset:2048
  s_mov_b32 s58, 128000
  s_mov_b64 vcc, -1
  s_nop 15
  s_nop 3
  global_atomic_or_x2 v[250:251], v5, v[76:77], s[50:51] sc0
  s_sleep 3
  global_atomic_or_x2 v[250:251], v5, v[76:77], s[50:51] sc0
  s_sleep 3
  global_atomic_or_x2 v[250:251], v5, v[76:77], s[50:51] sc0
  s_sleep 3
  global_atomic_or_x2 v[250:251], v5, v[76:77], s[50:51] sc0
L_g_18_c:
  s_waitcnt vmcnt(3)
  v_xor_b32 v20, s57, v250
  v_xor_b32 v21, s57, v251
  v_or_b32 v49, v20, v21
  v_cmp_ne_u32_sdwa vcc, v49, 0 src0_sel:BYTE_0 src1_sel:DWORD
  v_permlane32_swap_b32 v20, v21
  v_add_f32 v20, v20, v21
  v_mov_b32 v48, v20
  s_cbranch_vccnz L_g_18
  s_nop 0
  v_permlane16_swap_b32 v20, v48
  v_add_f32 v20, v20, v48
  s_nop 1
  v_add_f32_dpp v20, v20, v20 row_ror:8 row_mask:0xf bank_mask:0xf
  v_mov_b32 v21, v20
  s_nop 1
  v_permlane32_swap_b32 v20, v21
  v_add_f32 v20, v20, v13
  v_add_f32 v21, v21, v252
  v_cvt_pk_bf16_f32 v16, v20, v21
  s_mov_b64 exec, 0xff
  global_store_dword v254, v16, s[46:47] offset:-1024
  s_mov_b64 exec, -1
  global_load_short_d16_hi v222, v2, s[36:37] offset:2048 sc1
  global_load_short_d16_hi v223, v2, s[36:37] offset:2304 sc1
  global_load_short_d16_hi v224, v2, s[36:37] offset:2560 sc1
  global_load_short_d16_hi v225, v2, s[36:37] offset:2816 sc1
  global_load_short_d16_hi v226, v2, s[36:37] offset:3072 sc1
  global_load_short_d16_hi v227, v2, s[36:37] offset:3328 sc1
  global_load_short_d16_hi v228, v2, s[36:37] offset:3584 sc1
  global_load_short_d16_hi v229, v2, s[36:37] offset:3840 sc1
  v_readlane_b32 s4, v16, 0
  v_readlane_b32 s5, v16, 1
  v_readlane_b32 s6, v16, 2
  v_dot2c_f32_bf16 v40, s4, v212
  v_dot2c_f32_bf16 v41, s4, v84
  v_readlane_b32 s7, v16, 3
  v_dot2c_f32_bf16 v42, s4, v80
  v_dot2c_f32_bf16 v43, s4, v85
  v_dot2c_f32_bf16 v44, s4, v81
  v_dot2c_f32_bf16 v45, s4, v86
  v_dot2c_f32_bf16 v46, s4, v82
  v_dot2c_f32_bf16 v47, s4, v87
  v_dot2c_f32_bf16 v40, s5, v83
  v_dot2c_f32_bf16 v41, s5, v92
  v_readlane_b32 s8, v16, 4
  v_dot2c_f32_bf16 v42, s5, v88
  v_dot2c_f32_bf16 v43, s5, v93
  v_dot2c_f32_bf16 v44, s5, v89
  v_dot2c_f32_bf16 v45, s5, v94
  v_dot2c_f32_bf16 v46, s5, v90
  v_dot2c_f32_bf16 v47, s5, v95
  v_dot2c_f32_bf16 v40, s6, v91
  v_dot2c_f32_bf16 v41, s6, v100
  v_readlane_b32 s9, v16, 5
  v_dot2c_f32_bf16 v42, s6, v96
  v_dot2c_f32_bf16 v43, s6, v101
  v_dot2c_f32_bf16 v44, s6, v97
  v_dot2c_f32_bf16 v45, s6, v102
  v_dot2c_f32_bf16 v46, s6, v98
  v_dot2c_f32_bf16 v47, s6, v103
  v_dot2c_f32_bf16 v40, s7, v99
  v_dot2c_f32_bf16 v41, s7, v108
  v_readlane_b32 s10, v16, 6
  v_dot2c_f32_bf16 v42, s7, v104
  v_dot2c_f32_bf16 v43, s7, v109
  v_dot2c_f32_bf16 v44, s7, v105
  v_dot2c_f32_bf16 v45, s7, v110
  v_dot2c_f32_bf16 v46, s7, v106
  v_dot2c_f32_bf16 v47, s7, v111
  v_dot2c_f32_bf16 v40, s8, v107
  v_dot2c_f32_bf16 v41, s8, v116
  v_readlane_b32 s11, v16, 7
  v_dot2c_f32_bf16 v42, s8, v112
  v_dot2c_f32_bf16 v43, s8, v117
  v_dot2c_f32_bf16 v44, s8, v113
  v_dot2c_f32_bf16 v45, s8, v118
  v_dot2c_f32_bf16 v46, s8, v114
  v_dot2c_f32_bf16 v47, s8, v119
  v_dot2c_f32_bf16 v40, s9, v115
  v_dot2c_f32_bf16 v41, s9, v124
  v_dot2c_f32_bf16 v42, s9, v120
  v_dot2c_f32_bf16 v43, s9, v125
  v_dot2c_f32_bf16 v44, s9, v121
  v_dot2c_f32_bf16 v45, s9, v126
  v_dot2c_f32_bf16 v46, s9, v122
  v_dot2c_f32_bf16 v47, s9, v127
  v_dot2c_f32_bf16 v40, s10, v123
  v_dot2c_f32_bf16 v41, s10, v132
  v_dot2c_f32_bf16 v42, s10, v128
  v_dot2c_f32_bf16 v43, s10, v133
  v_dot2c_f32_bf16 v44, s10, v129
  v_dot2c_f32_bf16 v45, s10, v134
  v_dot2c_f32_bf16 v46, s10, v130
  v_dot2c_f32_bf16 v47, s10, v135
  v_dot2c_f32_bf16 v40, s11, v131
  v_dot2c_f32_bf16 v41, s11, v140
  v_dot2c_f32_bf16 v42, s11, v136
  v_dot2c_f32_bf16 v43, s11, v141
  v_dot2c_f32_bf16 v44, s11, v137
  v_dot2c_f32_bf16 v45, s11, v142
  v_dot2c_f32_bf16 v46, s11, v138
  v_dot2c_f32_bf16 v47, s11, v143
  global_load_dwordx4 v[238:241], v8, s[46:47] offset:-1024 sc1
  v_cvt_pk_bf16_f32 v48, v40, v41
  v_cvt_pk_bf16_f32 v49, v42, v43
  v_cvt_pk_bf16_f32 v50, v44, v45
  v_cvt_pk_bf16_f32 v51, v46, v47
  global_store_dwordx4 v3, v[48:51], s[36:37] offset:-2048
  v_lshlrev_b32 v13, 16, v16
  v_and_b32 v252, 0xffff0000, v16
  s_mov_b32 s65, 2000
  s_mov_b32 s58, 128000
  v_mov_b64 v[52:53], 0
  v_mov_b32 v54, 0x3b000000
  v_mov_b32 v55, 0x3727c5ac
  s_nop 14
  global_load_dwordx4 v[238:241], v8, s[46:47] offset:-1024 sc1
  s_nop 14
  global_load_dwordx4 v[238:241], v8, s[46:47] offset:-1024 sc1
  s_waitcnt vmcnt(4)
L_lcs_24:
  v_pk_add_f32 v[20:21], v[222:223], v[224:225]
  v_pk_add_f32 v[22:23], v[226:227], v[228:229]
  v_max3_u32 v48, v222, v223, v224
  v_max3_u32 v48, v48, v225, v226
  v_max3_u32 v48, v48, v227, v228
  v_max3_u32 v48, v48, v229, v229
  v_cmp_eq_u32 vcc, 0xffff0000, v48
  v_pk_add_f32 v[20:21], v[20:21], v[22:23]
  v_add_f32 v14, v20, v21
  s_cbranch_vccnz L_lcs_again_25
  v_mov_b32 v48, v14
  s_nop 1
  v_permlane32_swap_b32 v14, v48
  v_add_f32 v14, v14, v48
  v_mov_b32 v48, v14
  s_nop 1
  v_permlane16_swap_b32 v14, v48
  v_add_f32 v14, v14, v48
  s_waitcnt vmcnt(3)
  v_max3_u32 v48, v238, v239, v240
  v_max_u32 v48, v48, v241
  v_cmp_eq_u32 vcc, -1, v48
  s_cbranch_vccz L_xok_21
  s_waitcnt vmcnt(1)
  v_max3_u32 v48, v238, v239, v240
  v_max_u32 v48, v48, v241
  v_cmp_eq_u32 vcc, -1, v48
  s_cbranch_vccz L_xok_21
  s_waitcnt vmcnt(0)
  v_max3_u32 v48, v238, v239, v240
  v_max_u32 v48, v48, v241
  v_cmp_eq_u32 vcc, -1, v48
  s_cbranch_vccnz L_xretry_20
L_xok_21:
  v_dot2c_f32_bf16 v52, s64, v238
  v_dot2c_f32_bf16 v53, v238, v238
  v_dot2c_f32_bf16 v52, s64, v239
  v_dot2c_f32_bf16 v53, v239, v239
  v_dot2c_f32_bf16 v52, s64, v240
  v_dot2c_f32_bf16 v53, v240, v240
  v_dot2c_f32_bf16 v52, s64, v241
  v_dot2c_f32_bf16 v53, v241, v241
  global_load_short_d16_hi v214, v2, s[36:37] offset:-2048 sc1
  global_load_short_d16_hi v215, v2, s[36:37] offset:-1792 sc1
  global_load_short_d16_hi v216, v2, s[36:37] offset:-1536 sc1
  v_permlane32_swap_b32 v52, v53
  v_add_f32 v52, v52, v53
  v_mov_b32 v53, v52
  global_load_short_d16_hi v217, v2, s[36:37] offset:-1280 sc1
  global_load_short_d16_hi v218, v2, s[36:37] offset:-1024 sc1
  v_permlane16_swap_b32 v52, v53
  v_add_f32 v52, v52, v53
  global_load_short_d16_hi v219, v2, s[36:37] offset:-768 sc1
  global_load_short_d16_hi v220, v2, s[36:37] offset:-512 sc1
  v_add_f32_dpp v52, v52, v52 row_ror:8 row_mask:0xf bank_mask:0xf
  global_load_short_d16_hi v221, v2, s[36:37] offset:-256 sc1
  global_load_short_d16_hi v214, v2, s[36:37] offset:-2048 sc1
  v_add_f32_dpp v52, v52, v52 row_ror:4 row_mask:0xf bank_mask:0xf
  global_load_short_d16_hi v215, v2, s[36:37] offset:-1792 sc1
  global_load_short_d16_hi v216, v2, s[36:37] offset:-1536 sc1
  v_add_f32_dpp v52, v52, v52 row_ror:2 row_mask:0xf bank_mask:0xf
  global_load_short_d16_hi v217, v2, s[36:37] offset:-1280 sc1
  global_load_short_d16_hi v218, v2, s[36:37] offset:-1024 sc1
  v_add_f32_dpp v52, v52, v52 row_ror:1 row_mask:0xf bank_mask:0xf
  global_load_short_d16_hi v219, v2, s[36:37] offset:-768 sc1
  v_readlane_b32 s30, v52, 0
  v_readlane_b32 s31, v52, 32
  global_load_short_d16_hi v220, v2, s[36:37] offset:-512 sc1
  v_mul_f32 v17, s30, v54
  v_fma_f32 v18, s31, v54, v55
  v_fma_f32 v18, -v17, v17, v18
  v_max_f32 v18, v18, v55
  v_rsq_f32 v18, v18
  global_load_short_d16_hi v221, v2, s[36:37] offset:-256 sc1
  s_mov_b32 s58, 64
  v_mul_f32 v19, v17, v18
  v_mul_f32_e64 v19, -v19, v14
L_q_22_c:
  s_waitcnt vmcnt(12)
  v_pk_add_f32 v[20:21], v[214:215], v[216:217]
  s_waitcnt vmcnt(8)
  v_pk_add_f32 v[22:23], v[218:219], v[220:221]
  v_pk_add_f32 v[20:21], v[20:21], v[22:23]
  v_add_f32 v20, v20, v21
  v_mov_b32 v48, v20
  v_cmp_u_f32 vcc, v20, v20
  s_nop 0
  v_permlane32_swap_b32 v20, v48
  v_add_f32 v20, v20, v48
  v_mov_b32 v48, v20
  s_cbranch_vccnz L_q_22
L_q_done_19:
  s_nop 0
  v_permlane16_swap_b32 v20, v48
  v_add_f32 v20, v20, v48
  v_fma_f32 v20, v20, v18, v19
  s_nop 1
  v_mov_b32_dpp v48, v20 quad_perm:[1,0,3,2] row_mask:0xf bank_mask:0xf
  v_cvt_pk_bf16_f32 v16, v20, v48
  s_mov_b64 exec, 0x5555
  global_store_dword v7, v16, s[46:47] offset:-3072
  s_mov_b64 exec, -1
  global_store_dwordx4 v15, v[72:75], s[36:37] offset:-2048
  s_mov_b32 s58, 128000
  s_nop 15
  s_nop 15
  global_load_dwordx4 v[238:241], v79, s[46:47] offset:-3072 sc1
  s_nop 12
  global_load_dwordx4 v[238:241], v79, s[46:47] offset:-3072 sc1
  s_nop 12
L_aq_26:
  global_load_dwordx4 v[238:241], v79, s[46:47] offset:-3072 sc1
  s_sub_u32 s58, s58, 1
  s_cbranch_scc1 L_exit
  s_waitcnt vmcnt(2)
  v_max3_u32 v48, v238, v239, v240
  v_max_u32 v48, v48, v241
  v_cmp_eq_u32 vcc, -1, v48
  s_cbranch_vccnz L_aq_26
  ds_write_b128 v8, v[238:241] offset:41984
  s_waitcnt lgkmcnt(0)
  s_barrier
  v_mov_b32 v68, s64
  v_mov_b32 v69, s64
  v_mov_b32 v70, s64
  v_mov_b32 v71, s64
  s_barrier
  ds_read_b128 v[48:51], v8 offset:32768
  ds_read_b128 v[52:55], v8 offset:33792
  ds_read_b128 v[56:59], v8 offset:34816
  ds_read_b128 v[60:63], v8 offset:35840
  ds_read_b128 v[64:67], v12
  s_waitcnt lgkmcnt(4)
  v_mfma_f32_16x16x32_bf16 v[20:23], v[48:51], v[68:71], 0
  s_waitcnt lgkmcnt(3)
  v_mfma_f32_16x16x32_bf16 v[20:23], v[52:55], v[68:71], v[20:23]
  s_waitcnt lgkmcnt(2)
  v_mfma_f32_16x16x32_bf16 v[20:23], v[56:59], v[68:71], v[20:23]
  s_waitcnt lgkmcnt(1)
  v_mfma_f32_16x16x32_bf16 v[20:23], v[60:63], v[68:71], v[20:23]
  s_waitcnt lgkmcnt(0)
  v_or3_b32 v28, v64, v65, v66
  v_or_b32 v28, v28, v67
  v_cmp_ne_u32 vcc, 0, v28
  s_cbranch_vccnz L_cgen_28
  s_mov_b32 exec_lo, 0x00020002
  s_mov_b32 exec_hi, 0x00020002
L_cback_29:
  s_nop 0
  global_store_dword v10, v20, s[46:47] offset:2048
  s_mov_b64 exec, -1
  s_barrier
  v_mov_b64 v[40:41], 0
  v_mov_b64 v[42:43], 0
  v_mov_b64 v[44:45], 0
  v_mov_b64 v[46:47], 0
  s_add_u32 s57, s56, 13
  s_and_b32 s57, s57, 0x3f
  s_or_b32 s57, s57, 0x40
  s_barrier
  s_mov_b32 s65, 2000
  s_mov_b32 s58, 64
  s_nop 15
  s_nop 3
  global_load_short_d16_hi v214, v2, s[36:37] offset:-2048 sc1
  global_load_short_d16_hi v215, v2, s[36:37] offset:-1792 sc1
  global_load_short_d16_hi v216, v2, s[36:37] offset:-1536 sc1
  global_load_short_d16_hi v217, v2, s[36:37] offset:-1280 sc1
  global_load_short_d16_hi v218, v2, s[36:37] offset:-1024 sc1
  global_load_short_d16_hi v219, v2, s[36:37] offset:-768 sc1
  global_load_short_d16_hi v220, v2, s[36:37] offset:-512 sc1
  global_load_short_d16_hi v221, v2, s[36:37] offset:-256 sc1
  s_nop 14
  global_load_short_d16_hi v214, v2, s[36:37] offset:-2048 sc1
  global_load_short_d16_hi v215, v2, s[36:37] offset:-1792 sc1
  global_load_short_d16_hi v216, v2, s[36:37] offset:-1536 sc1
  global_load_short_d16_hi v217, v2, s[36:37] offset:-1280 sc1
  global_load_short_d16_hi v218, v2, s[36:37] offset:-1024 sc1
  global_load_short_d16_hi v219, v2, s[36:37] offset:-768 sc1
  global_load_short_d16_hi v220, v2, s[36:37] offset:-512 sc1
  global_load_short_d16_hi v221, v2, s[36:37] offset:-256 sc1
  s_nop 14
L_out_31:
  global_load_short_d16_hi v214, v2, s[36:37] offset:-2048 sc1
  global_load_short_d16_hi v215, v2, s[36:37] offset:-1792 sc1
  global_load_short_d16_hi v216, v2, s[36:37] offset:-1536 sc1
  global_load_short_d16_hi v217, v2, s[36:37] offset:-1280 sc1
  global_load_short_d16_hi v218, v2, s[36:37] offset:-1024 sc1
  global_load_short_d16_hi v219, v2, s[36:37] offset:-768 sc1
  global_load_short_d16_hi v220, v2, s[36:37] offset:-512 sc1
  global_load_short_d16_hi v221, v2, s[36:37] offset:-256 sc1
  s_sub_u32 s58, s58, 1
  s_cbranch_scc1 L_out_over_32
  s_waitcnt vmcnt(20)
  v_pk_add_f32 v[20:21], v[214:215], v[216:217]
  s_waitcnt vmcnt(16)
  v_pk_add_f32 v[22:23], v[218:219], v[220:221]
  v_pk_add_f32 v[20:21], v[20:21], v[22:23]
  v_add_f32 v20, v20, v21
  v_mov_b32 v48, v20
  v_cmp_u_f32 vcc, v20, v20
  s_nop 0
  v_permlane32_swap_b32 v20, v48
  v_add_f32 v20, v20, v48
  v_mov_b32 v48, v20
  s_cbranch_vccnz L_out_31
L_out_done_30:
  s_nop 0
  v_permlane16_swap_b32 v20, v48
  v_add_f32 v20, v20, v48
  v_bfi_b32 v20, v1, s57, v20
  s_mov_b32 exec_hi, 0
  global_atomic_swap v6, v20, s[52:53]
  s_mov_b64 exec, -1
  global_store_dwordx4 v15, v[72:75], s[36:37] offset:-2048
  s_cmp_eq_u32 s2, 0
  s_cbranch_scc0 L_noep_34
  s_add_u32 s30, s56, 16
  v_mov_b32 v48, s30
  s_mov_b64 exec, 1
  global_store_dword v76, v48, s[26:27] sc1
  s_mov_b64 exec, -1
L_noep_34:
  s_mov_b32 s58, 128000
  s_mov_b64 vcc, -1
  s_nop 15
  s_nop 3
  global_atomic_or_x2 v[250:251], v5, v[76:77], s[52:53] sc0
  s_sleep 3
  global_atomic_or_x2 v[250:251], v5, v[76:77], s[52:53] sc0
  s_sleep 3
  global_atomic_or_x2 v[250:251], v5, v[76:77], s[52:53] sc0
  s_sleep 3
  global_atomic_or_x2 v[250:251], v5, v[76:77], s[52:53] sc0
L_g_35_c:
  s_waitcnt vmcnt(3)
  v_xor_b32 v20, s57, v250
  v_xor_b32 v21, s57, v251
  v_or_b32 v49, v20, v21
  v_cmp_ne_u32_sdwa vcc, v49, 0 src0_sel:BYTE_0 src1_sel:DWORD
  v_permlane32_swap_b32 v20, v21
  v_add_f32 v20, v20, v21
  v_mov_b32 v48, v20
  s_cbranch_vccnz L_g_35
  s_nop 0
  v_permlane16_swap_b32 v20, v48
  v_add_f32 v20, v20, v48
  s_nop 1
  v_add_f32_dpp v20, v20, v20 row_ror:8 row_mask:0xf bank_mask:0xf
  v_mov_b32 v21, v20
  s_nop 1
  v_permlane32_swap_b32 v20, v21
  v_add_f32 v20, v20, v13
  v_add_f32 v21, v21, v252
  v_cvt_pk_bf16_f32 v16, v20, v21
  s_mov_b64 exec, 0xff
  global_store_dword v254, v16, s[46:47] offset:0
  s_mov_b64 exec, -1
  s_barrier
  v_readlane_b32 s4, v16, 0
  v_readlane_b32 s5, v16, 1
  v_readlane_b32 s6, v16, 2
  v_dot2c_f32_bf16 v40, s4, v139
  v_dot2c_f32_bf16 v41, s4, v148
  v_readlane_b32 s7, v16, 3
  v_dot2c_f32_bf16 v42, s4, v144
  v_dot2c_f32_bf16 v43, s4, v149
  v_dot2c_f32_bf16 v44, s4, v145
  v_dot2c_f32_bf16 v45, s4, v150
  v_dot2c_f32_bf16 v46, s4, v146
  v_dot2c_f32_bf16 v47, s4, v151
  v_dot2c_f32_bf16 v40, s5, v147
  v_dot2c_f32_bf16 v41, s5, v156
  v_readlane_b32 s8, v16, 4
  v_dot2c_f32_bf16 v42, s5, v152
  v_dot2c_f32_bf16 v43, s5, v157
  v_dot2c_f32_bf16 v44, s5, v153
  v_dot2c_f32_bf16 v45, s5, v158
  v_dot2c_f32_bf16 v46, s5, v154
  v_dot2c_f32_bf16 v47, s5, v159
  v_dot2c_f32_bf16 v40, s6, v155
  v_dot2c_f32_bf16 v41, s6, v164
  v_readlane_b32 s9, v16, 5
  v_dot2c_f32_bf16 v42, s6, v160
  v_dot2c_f32_bf16 v43, s6, v165
  v_dot2c_f32_bf16 v44, s6, v161
  v_dot2c_f32_bf16 v45, s6, v166
  v_dot2c_f32_bf16 v46, s6, v162
  v_dot2c_f32_bf16 v47, s6, v167
  v_dot2c_f32_bf16 v40, s7, v163
  v_dot2c_f32_bf16 v41, s7, v172
  v_readlane_b32 s10, v16, 6
  v_dot2c_f32_bf16 v42, s7, v168
  v_dot2c_f32_bf16 v43, s7, v173
  v_dot2c_f32_bf16 v44, s7, v169
  v_dot2c_f32_bf16 v45, s7, v174
  v_dot2c_f32_bf16 v46, s7, v170
  v_dot2c_f32_bf16 v47, s7, v175
  v_dot2c_f32_bf16 v40, s8, v171
  v_dot2c_f32_bf16 v41, s8, v180
  v_readlane_b32 s11, v16, 7
  v_dot2c_f32_bf16 v42, s8, v176
  v_dot2c_f32_bf16 v43, s8, v181
  v_dot2c_f32_bf16 v44, s8, v177
  v_dot2c_f32_bf16 v45, s8, v182
  v_dot2c_f32_bf16 v46, s8, v178
  v_dot2c_f32_bf16 v47, s8, v183
  v_dot2c_f32_bf16 v40, s9, v179
  v_dot2c_f32_bf16 v41, s9, v188
  v_dot2c_f32_bf16 v42, s9, v184
  v_dot2c_f32_bf16 v43, s9, v189
  v_dot2c_f32_bf16 v44, s9, v185
  v_dot2c_f32_bf16 v45, s9, v190
  v_dot2c_f32_bf16 v46, s9, v186
  v_dot2c_f32_bf16 v47, s9, v191
  v_dot2c_f32_bf16 v40, s10, v187
  v_dot2c_f32_bf16 v41, s10, v196
  v_dot2c_f32_bf16 v42, s10, v192
  v_dot2c_f32_bf16 v43, s10, v197
  v_dot2c_f32_bf16 v44, s10, v193
  v_dot2c_f32_bf16 v45, s10, v198
  v_dot2c_f32_bf16 v46, s10, v194
  v_dot2c_f32_bf16 v47, s10, v199
  v_dot2c_f32_bf16 v40, s11, v195
  v_dot2c_f32_bf16 v41, s11, v204
  v_dot2c_f32_bf16 v42, s11, v200
  v_dot2c_f32_bf16 v43, s11, v205
  v_dot2c_f32_bf16 v44, s11, v201
  v_dot2c_f32_bf16 v45, s11, v206
  v_dot2c_f32_bf16 v46, s11, v202
  v_dot2c_f32_bf16 v47, s11, v207
  v_cvt_pk_bf16_f32 v48, v40, v41
  v_cvt_pk_bf16_f32 v49, v42, v43
  v_cvt_pk_bf16_f32 v50, v44, v45
  v_cvt_pk_bf16_f32 v51, v46, v47
  s_mov_b64 exec, s[14:15]
  global_store_dwordx4 v3, v[48:51], s[36:37] offset:0
  s_mov_b64 exec, -1
  v_lshlrev_b32 v13, 16, v16
  v_and_b32 v252, 0xffff0000, v16
  v_mov_b64 v[40:41], 0
  v_mov_b64 v[42:43], 0
  v_mov_b64 v[44:45], 0
  v_mov_b64 v[46:47], 0
  s_add_u32 s57, s56, 14
  s_and_b32 s57, s57, 0x3f
  s_or_b32 s57, s57, 0x40
  s_barrier
  v_and_b32 v64, 7, v0
  v_lshlrev_b32 v64, 3, v64
  s_mov_b64 s[24:25], 0xff
  s_lshl_b64 s[24:25], s[24:25], 32
  s_mov_b32 s65, 2000
  s_mov_b32 s58, 64
  s_nop 15
  s_nop 3
  global_load_short_d16_hi v214, v2, s[36:37] offset:-2048 sc1
  global_load_short_d16_hi v215, v2, s[36:37] offset:-1792 sc1
  global_load_short_d16_hi v216, v2, s[36:37] offset:-1536 sc1
  global_load_short_d16_hi v217, v2, s[36:37] offset:-1280 sc1
  global_load_short_d16_hi v218, v2, s[36:37] offset:-1024 sc1
  global_load_short_d16_hi v219, v2, s[36:37] offset:-768 sc1
  global_load_short_d16_hi v220, v2, s[36:37] offset:-512 sc1
  s_nop 14
  global_load_short_d16_hi v214, v2, s[36:37] offset:-2048 sc1
  global_load_short_d16_hi v215, v2, s[36:37] offset:-1792 sc1
  global_load_short_d16_hi v216, v2, s[36:37] offset:-1536 sc1
  global_load_short_d16_hi v217, v2, s[36:37] offset:-1280 sc1
  global_load_short_d16_hi v218, v2, s[36:37] offset:-1024 sc1
  global_load_short_d16_hi v219, v2, s[36:37] offset:-768 sc1
  global_load_short_d16_hi v220, v2, s[36:37] offset:-512 sc1
  s_nop 14
L_out_37:
  global_load_short_d16_hi v214, v2, s[36:37] offset:-2048 sc1
  global_load_short_d16_hi v215, v2, s[36:37] offset:-1792 sc1
  global_load_short_d16_hi v216, v2, s[36:37] offset:-1536 sc1
  global_load_short_d16_hi v217, v2, s[36:37] offset:-1280 sc1
  global_load_short_d16_hi v218, v2, s[36:37] offset:-1024 sc1
  global_load_short_d16_hi v219, v2, s[36:37] offset:-768 sc1
  global_load_short_d16_hi v220, v2, s[36:37] offset:-512 sc1
  s_sub_u32 s58, s58, 1
  s_cbranch_scc1 L_out_over_38
  s_waitcnt vmcnt(17)
  v_pk_add_f32 v[20:21], v[214:215], v[216:217]
  s_waitcnt vmcnt(14)
  v_pk_add_f32 v[20:21], v[20:21], v[218:219]
  v_add_f32 v20, v20, v220
  v_add_f32 v20, v20, v21
  v_mov_b32 v48, v20
  v_cmp_u_f32 vcc, v20, v20
  s_nop 0
  v_permlane32_swap_b32 v20, v48
  v_add_f32 v20, v20, v48
  v_mov_b32 v48, v20
  s_cbranch_vccnz L_out_37
L_out_done_36:
  s_cmp_eq_u32 s28, 4
  v_permlane16_swap_b32 v20, v48
  v_add_f32 v20, v20, v48
  v_bfi_b32 v20, v1, s57, v20
  s_cbranch_scc0 L_lastpub_39
  s_not_b64 vcc, s[24:25]
  s_mov_b64 exec, vcc
  global_atomic_or_x2 v[250:251], v5, v[76:77], s[54:55] sc0
  s_mov_b64 exec, -1
  ds_bpermute_b32 v66, v64, v20
  ds_bpermute_b32 v67, v64, v20 offset:4
  s_mov_b32 s58, 128000
  s_waitcnt lgkmcnt(0)
  s_mov_b64 exec, s[24:25]
  v_mov_b64 v[250:251], v[66:67]
  s_mov_b64 exec, -1
  s_nop 15
  s_nop 15
  s_nop 4
  s_mov_b64 exec, vcc
  global_atomic_or_x2 v[250:251], v5, v[76:77], s[54:55] sc0
  s_mov_b64 exec, -1
  s_nop 15
  s_nop 13
  s_mov_b64 exec, vcc
  global_atomic_or_x2 v[250:251], v5, v[76:77], s[54:55] sc0
  s_mov_b64 exec, -1
L_g_41_c:
  s_waitcnt vmcnt(2)
  v_xor_b32 v20, s57, v250
  v_xor_b32 v21, s57, v251
  v_or_b32 v49, v20, v21
  v_cmp_ne_u32_sdwa vcc, v49, 0 src0_sel:BYTE_0 src1_sel:DWORD
  v_permlane32_swap_b32 v20, v21
  v_add_f32 v20, v20, v21
  v_mov_b32 v48, v20
  s_cbranch_vccnz L_g_41
  s_nop 0
  v_permlane16_swap_b32 v20, v48
  v_add_f32 v20, v20, v48
  s_nop 1
  v_add_f32_dpp v20, v20, v20 row_ror:8 row_mask:0xf bank_mask:0xf
  v_mov_b32 v21, v20
  s_nop 1
  v_permlane32_swap_b32 v20, v21
  v_add_f32 v20, v20, v13
  v_add_f32 v21, v21, v252
  v_cvt_pk_bf16_f32 v16, v20, v21
  s_mov_b64 exec, 0xff
  global_store_dword v254, v16, s[22:23] offset:0
  s_mov_b64 exec, -1
L_fin_40:
  s_endpgm
L_q0_over_3:
  s_branch L_Xslow
L_cgen_6:
  s_nop 7
  v_mfma_f32_16x16x32_bf16 v[28:31], v[48:51], v[68:71], 0
  v_mfma_f32_16x16x32_bf16 v[32:35], v[52:55], v[68:71], 0
  v_mfma_f32_16x16x32_bf16 v[40:43], v[56:59], v[68:71], 0
  v_mfma_f32_16x16x32_bf16 v[44:47], v[60:63], v[68:71], 0
  v_max3_f32 v20, v64, v65, v66
  v_max_f32 v20, v20, v67
  v_sub_f32 v64, v64, v20
  v_sub_f32 v65, v65, v20
  v_sub_f32 v66, v66, v20
  v_sub_f32 v67, v67, v20
  v_exp_f32 v64, v64
  v_exp_f32 v65, v65
  v_exp_f32 v66, v66
  v_exp_f32 v67, v67
  v_mul_f32 v21, v64, v28
  v_fmac_f32 v21, v65, v32
  v_fmac_f32 v21, v66, v40
  v_fmac_f32 v21, v67, v44
  v_or_b32 v21, 0x80000000, v21
  v_cndmask_b32 v20, v20, v21, s[66:67]
  s_mov_b32 exec_lo, 0x00030003
  s_mov_b32 exec_hi, 0x00030003
  s_branch L_cback_7
L_out_over_11:
  s_sub_u32 s65, s65, 1
  s_cbranch_scc1 L_exit
  s_mov_b32 s58, 64
  s_waitcnt vmcnt(0)
  v_max3_u32 v48, v214, v215, v216
  v_max3_u32 v48, v48, v217, v218
  v_max3_u32 v48, v48, v219, v220
  v_max3_u32 v48, v48, v221, v221
  v_cmp_eq_u32 vcc, 0xffff0000, v48
  s_cbranch_vccnz L_out_10
  s_waitcnt vmcnt(4)
  v_pk_add_f32 v[20:21], v[214:215], v[216:217]
  s_waitcnt vmcnt(0)
  v_pk_add_f32 v[22:23], v[218:219], v[220:221]
  v_pk_add_f32 v[20:21], v[20:21], v[22:23]
  v_add_f32 v20, v20, v21
  v_mov_b32 v48, v20
  s_nop 1
  v_permlane32_swap_b32 v20, v48
  v_add_f32 v20, v20, v48
  v_mov_b32 v48, v20
  s_branch L_out_done_9
L_g_13:
  s_mov_b64 exec, vcc
  global_atomic_or_x2 v[250:251], v5, v[76:77], s[48:49] sc0
  s_mov_b64 exec, -1
  s_sub_u32 s58, s58, 1
  s_cbranch_scc0 L_g_13_c
  s_endpgm
L_out_over_16:
  s_sub_u32 s65, s65, 1
  s_cbranch_scc1 L_exit
  s_mov_b32 s58, 64
  s_waitcnt vmcnt(0)
  v_max3_u32 v48, v214, v215, v216
  v_max3_u32 v48, v48, v217, v218
  v_max3_u32 v48, v48, v219, v220
  v_cmp_eq_u32 vcc, 0xffff0000, v48
  s_cbranch_vccnz L_out_15
  s_waitcnt vmcnt(3)
  v_pk_add_f32 v[20:21], v[214:215], v[216:217]
  s_waitcnt vmcnt(0)
  v_pk_add_f32 v[20:21], v[20:21], v[218:219]
  v_add_f32 v20, v20, v220
  v_add_f32 v20, v20, v21
  v_mov_b32 v48, v20
  s_nop 1
  v_permlane32_swap_b32 v20, v48
  v_add_f32 v20, v20, v48
  v_mov_b32 v48, v20
  s_branch L_out_done_14
L_g_18:
  s_mov_b64 exec, vcc
  global_atomic_or_x2 v[250:251], v5, v[76:77], s[50:51] sc0
  s_mov_b64 exec, -1
  s_sub_u32 s58, s58, 1
  s_cbranch_scc0 L_g_18_c
  s_endpgm
L_lcs_again_25:
  global_load_short_d16_hi v222, v2, s[36:37] offset:2048 sc1
  global_load_short_d16_hi v223, v2, s[36:37] offset:2304 sc1
  global_load_short_d16_hi v224, v2, s[36:37] offset:2560 sc1
  global_load_short_d16_hi v225, v2, s[36:37] offset:2816 sc1
  global_load_short_d16_hi v226, v2, s[36:37] offset:3072 sc1
  global_load_short_d16_hi v227, v2, s[36:37] offset:3328 sc1
  global_load_short_d16_hi v228, v2, s[36:37] offset:3584 sc1
  global_load_short_d16_hi v229, v2, s[36:37] offset:3840 sc1
  s_waitcnt vmcnt(0)
  s_sub_u32 s58, s58, 1
  s_cbranch_scc0 L_lcs_24
  s_endpgm
L_xretry_20:
  global_load_dwordx4 v[238:241], v8, s[46:47] offset:-1024 sc1
  s_nop 15
L_xretry_20_b:
  global_load_dwordx4 v[238:241], v8, s[46:47] offset:-1024 sc1
  s_sub_u32 s58, s58, 1
  s_cbranch_scc1 L_exit
  s_waitcnt vmcnt(1)
  v_max3_u32 v48, v238, v239, v240
  v_max_u32 v48, v48, v241
  v_cmp_eq_u32 vcc, -1, v48
  s_cbranch_vccnz L_xretry_20_b
  s_branch L_xok_21
L_q_22:
  global_load_short_d16_hi v214, v2, s[36:37] offset:-2048 sc1
  global_load_short_d16_hi v215, v2, s[36:37] offset:-1792 sc1
  global_load_short_d16_hi v216, v2, s[36:37] offset:-1536 sc1
  global_load_short_d16_hi v217, v2, s[36:37] offset:-1280 sc1
  global_load_short_d16_hi v218, v2, s[36:37] offset:-1024 sc1
  global_load_short_d16_hi v219, v2, s[36:37] offset:-768 sc1
  global_load_short_d16_hi v220, v2, s[36:37] offset:-512 sc1
  global_load_short_d16_hi v221, v2, s[36:37] offset:-256 sc1
  s_sub_u32 s58, s58, 1
  s_cbranch_scc0 L_q_22_c
  s_branch L_q_over_23
L_q_over_23:
  s_sub_u32 s65, s65, 1
  s_cbranch_scc1 L_exit
  s_mov_b32 s58, 64
  s_waitcnt vmcnt(0)
  v_max3_u32 v48, v214, v215, v216
  v_max3_u32 v48, v48, v217, v218
  v_max3_u32 v48, v48, v219, v220
  v_max3_u32 v48, v48, v221, v221
  v_cmp_eq_u32 vcc, 0xffff0000, v48
  s_cbranch_vccnz L_q_22
  s_waitcnt vmcnt(4)
  v_pk_add_f32 v[20:21], v[214:215], v[216:217]
  s_waitcnt vmcnt(0)
  v_pk_add_f32 v[22:23], v[218:219], v[220:221]
  v_pk_add_f32 v[20:21], v[20:21], v[22:23]
  v_add_f32 v20, v20, v21
  v_mov_b32 v48, v20
  s_nop 1
  v_permlane32_swap_b32 v20, v48
  v_add_f32 v20, v20, v48
  v_mov_b32 v48, v20
  s_branch L_q_done_19
L_cgen_28:
  s_nop 7
  v_mfma_f32_16x16x32_bf16 v[28:31], v[48:51], v[68:71], 0
  v_mfma_f32_16x16x32_bf16 v[32:35], v[52:55], v[68:71], 0
  v_mfma_f32_16x16x32_bf16 v[40:43], v[56:59], v[68:71], 0
  v_mfma_f32_16x16x32_bf16 v[44:47], v[60:63], v[68:71], 0
  v_max3_f32 v20, v64, v65, v66
  v_max_f32 v20, v20, v67
  v_sub_f32 v64, v64, v20
  v_sub_f32 v65, v65, v20
  v_sub_f32 v66, v66, v20
  v_sub_f32 v67, v67, v20
  v_exp_f32 v64, v64
  v_exp_f32 v65, v65
  v_exp_f32 v66, v66
  v_exp_f32 v67, v67
  v_mul_f32 v21, v64, v28
  v_fmac_f32 v21, v65, v32
  v_fmac_f32 v21, v66, v40
  v_fmac_f32 v21, v67, v44
  v_or_b32 v21, 0x80000000, v21
  v_cndmask_b32 v20, v20, v21, s[66:67]
  s_mov_b32 exec_lo, 0x00030003
  s_mov_b32 exec_hi, 0x00030003
  s_branch L_cback_29
L_out_over_32:
  s_sub_u32 s65, s65, 1
  s_cbranch_scc1 L_exit
  s_mov_b32 s58, 64
  s_waitcnt vmcnt(0)
  v_max3_u32 v48, v214, v215, v216
  v_max3_u32 v48, v48, v217, v218
  v_max3_u32 v48, v48, v219, v220
  v_max3_u32 v48, v48, v221, v221
  v_cmp_eq_u32 vcc, 0xffff0000, v48
  s_cbranch_vccnz L_out_31
  s_waitcnt vmcnt(4)
  v_pk_add_f32 v[20:21], v[214:215], v[216:217]
  s_waitcnt vmcnt(0)
  v_pk_add_f32 v[22:23], v[218:219], v[220:221]
  v_pk_add_f32 v[20:21], v[20:21], v[22:23]
  v_add_f32 v20, v20, v21
  v_mov_b32 v48, v20
  s_nop 1
  v_permlane32_swap_b32 v20, v48
  v_add_f32 v20, v20, v48
  v_mov_b32 v48, v20
  s_branch L_out_done_30
L_g_35:
  s_mov_b64 exec, vcc
  global_atomic_or_x2 v[250:251], v5, v[76:77], s[52:53] sc0
  s_mov_b64 exec, -1
  s_sub_u32 s58, s58, 1
  s_cbranch_scc0 L_g_35_c
  s_endpgm
L_out_over_38:
  s_sub_u32 s65, s65, 1
  s_cbranch_scc1 L_exit
  s_mov_b32 s58, 64
  s_waitcnt vmcnt(0)
  v_max3_u32 v48, v214, v215, v216
  v_max3_u32 v48, v48, v217, v218
  v_max3_u32 v48, v48, v219, v220
  v_cmp_eq_u32 vcc, 0xffff0000, v48
  s_cbranch_vccnz L_out_37
  s_waitcnt vmcnt(3)
  v_pk_add_f32 v[20:21], v[214:215], v[216:217]
  s_waitcnt vmcnt(0)
  v_pk_add_f32 v[20:21], v[20:21], v[218:219]
  v_add_f32 v20, v20, v220
  v_add_f32 v20, v20, v21
  v_mov_b32 v48, v20
  s_nop 1
  v_permlane32_swap_b32 v20, v48
  v_add_f32 v20, v20, v48
  v_mov_b32 v48, v20
  s_branch L_out_done_36
L_lastpub_39:
  s_mov_b32 exec_hi, 0
  global_atomic_swap v6, v20, s[54:55]
  s_mov_b64 exec, -1
  s_endpgm
L_g_41:
  s_mov_b64 exec, vcc
  global_atomic_or_x2 v[250:251], v5, v[76:77], s[54:55] sc0
  s_mov_b64 exec, -1
  s_sub_u32 s58, s58, 1
  s_cbranch_scc0 L_g_41_c
  s_endpgm
L_Y:
  v_mov_b64 v[48:49], 0
  ds_write_b64 v76, v[48:49] offset:41096
  ds_write_b32 v76, v48 offset:41092
  ds_write_b32 v76, v48 offset:41108
  v_add_u32 v64, 75776, v8
  s_waitcnt lgkmcnt(0)
  s_barrier
  s_mov_b32 s8, 0
  s_lshl_b32 s30, s28, 14
  s_and_b32 s31, s29, 15
  s_lshl_b32 s31, s31, 8
  s_add_u32 s30, s30, s31
  s_lshr_b32 s31, s29, 4
  s_lshl_b32 s31, s31, 17
  s_add_u32 s30, s30, s31
  s_add_u32 s30, s30, 524288
  s_add_u32 s16, s26, s30
  s_addc_u32 s17, s27, 0
  s_and_b32 s21, s29, 1
  s_lshl_b32 s10, s21, 13
  s_xor_b32 s11, s10, 0x2000
  s_add_u32 s10, s10, 128
  s_add_u32 s11, s11, 128
  s_memtime s[18:19]
  s_waitcnt lgkmcnt(0)
  s_load_dword s20, s[16:17], s10
  s_waitcnt lgkmcnt(0)
  s_memtime s[6:7]
  s_waitcnt lgkmcnt(0)
  s_load_dword s20, s[16:17], s11
  s_waitcnt lgkmcnt(0)
  s_memtime s[8:9]
  s_waitcnt lgkmcnt(0)
  s_sub_u32 s8, s8, s6
  s_sub_u32 s6, s6, s18
  s_sub_u32 s8, s6, s8
  s_sub_u32 s9, 0, s8
  s_cmp_eq_u32 s21, 0
  s_cselect_b32 s8, s8, s9
L_noprobe_42:
  s_sub_u32 s9, 0, s8
  s_cmp_ge_u32 s61, 4
  s_cselect_b32 s8, s8, s9
  s_min_i32 s8, s8, 1000
  s_max_i32 s8, s8, -1000
  v_mov_b32 v48, s8
  ds_write_b32 v76, v48 offset:41104
  s_add_u32 s25, s56, 3
  s_and_b32 s25, s25, 0xffff
  s_lshl_b32 s24, s8, 16
  s_or_b32 s24, s24, s25
  v_mov_b32 v48, s24
  s_lshl_b32 s30, s29, 2
  v_mov_b32 v49, s30
  s_mov_b64 exec, 1
  global_store_dword v49, v48, s[46:47] offset:3328
  s_mov_b64 exec, -1
  s_mov_b32 s65, 512000
L_cnt_43:
  ds_read_b32 v49, v76 offset:41096
  s_sub_u32 s65, s65, 1
  s_cbranch_scc1 L_exit
  s_waitcnt lgkmcnt(0)
  v_cmp_gt_u32 vcc, 1, v49
  s_cbranch_vccnz L_cnt_43
  v_xor_b32 v50, 0, v208
  global_load_dwordx4 v[80:83], v50, s[12:13] nt
  v_xor_b32 v50, 16384, v208
  global_load_dwordx4 v[84:87], v50, s[12:13] nt
  v_xor_b32 v50, 2048, v208
  global_load_dwordx4 v[88:91], v50, s[12:13] nt
  v_xor_b32 v50, 18432, v208
  global_load_dwordx4 v[92:95], v50, s[12:13] nt
L_cnt_44:
  ds_read_b32 v49, v76 offset:41096
  s_sub_u32 s65, s65, 1
  s_cbranch_scc1 L_exit
  s_waitcnt lgkmcnt(0)
  v_cmp_gt_u32 vcc, 2, v49
  s_cbranch_vccnz L_cnt_44
  v_xor_b32 v50, 4096, v208
  global_load_dwordx4 v[96:99], v50, s[12:13] nt
  v_xor_b32 v50, 20480, v208
  global_load_dwordx4 v[100:103], v50, s[12:13] nt
  v_xor_b32 v50, 6144, v208
  global_load_dwordx4 v[104:107], v50, s[12:13] nt
  v_xor_b32 v50, 22528, v208
  global_load_dwordx4 v[108:111], v50, s[12:13] nt
L_cnt_45:
  ds_read_b32 v49, v76 offset:41096
  s_sub_u32 s65, s65, 1
  s_cbranch_scc1 L_exit
  s_waitcnt lgkmcnt(0)
  v_cmp_gt_u32 vcc, 3, v49
  s_cbranch_vccnz L_cnt_45
  v_xor_b32 v50, 8192, v208
  global_load_dwordx4 v[112:115], v50, s[12:13] nt
  v_xor_b32 v50, 24576, v208
  global_load_dwordx4 v[116:119], v50, s[12:13] nt
  v_xor_b32 v50, 10240, v208
  global_load_dwordx4 v[120:123], v50, s[12:13] nt
  v_xor_b32 v50, 26624, v208
  global_load_dwordx4 v[124:127], v50, s[12:13] nt
L_cnt_46:
  ds_read_b32 v49, v76 offset:41096
  s_sub_u32 s65, s65, 1
  s_cbranch_scc1 L_exit
  s_waitcnt lgkmcnt(0)
  v_cmp_gt_u32 vcc, 4, v49
  s_cbranch_vccnz L_cnt_46
  v_xor_b32 v50, 12288, v208
  global_load_dwordx4 v[128:131], v50, s[12:13] nt
  v_xor_b32 v50, 28672, v208
  global_load_dwordx4 v[132:135], v50, s[12:13] nt
  v_xor_b32 v50, 14336, v208
  global_load_dwordx4 v[136:139], v50, s[12:13] nt
  v_xor_b32 v50, 30720, v208
  global_load_dwordx4 v[140:143], v50, s[12:13] nt
  s_barrier
  ds_read_b32 v49, v76 offset:41088
  s_waitcnt lgkmcnt(0)
  v_readfirstlane_b32 s3, v49
  s_nop 1
  s_cmp_eq_u32 s3, 0
  s_cbranch_scc0 L_Yslow
  s_barrier
  s_barrier
  global_load_dword v250, v253, s[46:47] offset:3328 sc1
  v_mov_b64 v[40:41], 0
  v_mov_b64 v[42:43], 0
  v_mov_b64 v[44:45], 0
  v_mov_b64 v[46:47], 0
  s_mov_b32 s65, 2000
  s_mov_b32 s58, 64
  global_load_dwordx4 v[230:233], v9, s[46:47] offset:1152 sc1
  global_load_dwordx4 v[234:237], v9, s[46:47] offset:1168 sc1
  global_load_short_d16_hi v214, v2, s[36:37] offset:-2048 sc1
  global_load_short_d16_hi v215, v2, s[36:37] offset:-1792 sc1
  global_load_short_d16_hi v216, v2, s[36:37] offset:-1536 sc1
  global_load_short_d16_hi v217, v2, s[36:37] offset:-1280 sc1
  global_load_short_d16_hi v218, v2, s[36:37] offset:-1024 sc1
  global_load_short_d16_hi v219, v2, s[36:37] offset:-768 sc1
  global_load_short_d16_hi v220, v2, s[36:37] offset:-512 sc1
  global_load_short_d16_hi v221, v2, s[36:37] offset:-256 sc1
  v_add_u32 v64, 75776, v8
  s_mov_b32 s65, 512000
L_cnt_52:
  ds_read_b32 v49, v76 offset:41100
  s_sub_u32 s65, s65, 1
  s_cbranch_scc1 L_exit
  s_waitcnt lgkmcnt(0)
  v_cmp_gt_u32 vcc, 4, v49
  s_cbranch_vccnz L_cnt_52
  ds_read_b128 v[144:147], v64 offset:0
  ds_read_b128 v[148:151], v64 offset:1024
  ds_read_b128 v[152:155], v64 offset:2048
  ds_read_b128 v[156:159], v64 offset:3072
  ds_read_b128 v[160:163], v64 offset:4096
  ds_read_b128 v[164:167], v64 offset:5120
  ds_read_b128 v[168:171], v64 offset:6144
  ds_read_b128 v[172:175], v64 offset:7168
  s_waitcnt lgkmcnt(6)
  v_perm_b32 v212, v148, v144, s62
  v_perm_b32 v148, v148, v144, s63
  v_perm_b32 v144, v149, v145, s62
  v_perm_b32 v149, v149, v145, s63
  v_perm_b32 v145, v150, v146, s62
  v_perm_b32 v150, v150, v146, s63
  v_perm_b32 v146, v151, v147, s62
  v_perm_b32 v151, v151, v147, s63
  s_waitcnt lgkmcnt(4)
  v_perm_b32 v147, v156, v152, s62
  v_perm_b32 v156, v156, v152, s63
  v_perm_b32 v152, v157, v153, s62
  v_perm_b32 v157, v157, v153, s63
  v_perm_b32 v153, v158, v154, s62
  v_perm_b32 v158, v158, v154, s63
  v_perm_b32 v154, v159, v155, s62
  v_perm_b32 v159, v159, v155, s63
  s_waitcnt lgkmcnt(2)
  v_perm_b32 v155, v164, v160, s62
  v_perm_b32 v164, v164, v160, s63
  v_perm_b32 v160, v165, v161, s62
  v_perm_b32 v165, v165, v161, s63
  v_perm_b32 v161, v166, v162, s62
  v_perm_b32 v166, v166, v162, s63
  v_perm_b32 v162, v167, v163, s62
  v_perm_b32 v167, v167, v163, s63
  s_waitcnt lgkmcnt(0)
  v_perm_b32 v163, v172, v168, s62
  v_perm_b32 v172, v172, v168, s63
  v_perm_b32 v168, v173, v169, s62
  v_perm_b32 v173, v173, v169, s63
  v_perm_b32 v169, v174, v170, s62
  v_perm_b32 v174, v174, v170, s63
  v_perm_b32 v170, v175, v171, s62
  v_perm_b32 v175, v175, v171, s63
  s_mov_b32 s65, 2000
  s_waitcnt vmcnt(25)
  v_perm_b32 v171, v84, v80, s62
  v_perm_b32 v84, v84, v80, s63
  v_perm_b32 v80, v85, v81, s62
  v_perm_b32 v85, v85, v81, s63
  v_perm_b32 v81, v86, v82, s62
  v_perm_b32 v86, v86, v82, s63
  v_perm_b32 v82, v87, v83, s62
  v_perm_b32 v87, v87, v83, s63
  s_waitcnt vmcnt(23)
  v_perm_b32 v83, v92, v88, s62
  v_perm_b32 v92, v92, v88, s63
  v_perm_b32 v88, v93, v89, s62
  v_perm_b32 v93, v93, v89, s63
  v_perm_b32 v89, v94, v90, s62
  v_perm_b32 v94, v94, v90, s63
  v_perm_b32 v90, v95, v91, s62
  v_perm_b32 v95, v95, v91, s63
  s_waitcnt vmcnt(21)
  v_perm_b32 v91, v100, v96, s62
  v_perm_b32 v100, v100, v96, s63
  v_perm_b32 v96, v101, v97, s62
  v_perm_b32 v101, v101, v97, s63
  v_perm_b32 v97, v102, v98, s62
  v_perm_b32 v102, v102, v98, s63
  v_perm_b32 v98, v103, v99, s62
  v_perm_b32 v103, v103, v99, s63
  s_waitcnt vmcnt(19)
  v_perm_b32 v99, v108, v104, s62
  v_perm_b32 v108, v108, v104, s63
  v_perm_b32 v104, v109, v105, s62
  v_perm_b32 v109, v109, v105, s63
  v_perm_b32 v105, v110, v106, s62
  v_perm_b32 v110, v110, v106, s63
  v_perm_b32 v106, v111, v107, s62
  v_perm_b32 v111, v111, v107, s63
  s_waitcnt vmcnt(17)
  v_perm_b32 v107, v116, v112, s62
  v_perm_b32 v116, v116, v112, s63
  v_perm_b32 v112, v117, v113, s62
  v_perm_b32 v117, v117, v113, s63
  v_perm_b32 v113, v118, v114, s62
  v_perm_b32 v118, v118, v114, s63
  v_perm_b32 v114, v119, v115, s62
  v_perm_b32 v119, v119, v115, s63
  s_waitcnt vmcnt(15)
  v_perm_b32 v115, v124, v120, s62
  v_perm_b32 v124, v124, v120, s63
  v_perm_b32 v120, v125, v121, s62
  v_perm_b32 v125, v125, v121, s63
  v_perm_b32 v121, v126, v122, s62
  v_perm_b32 v126, v126, v122, s63
  v_perm_b32 v122, v127, v123, s62
  v_perm_b32 v127, v127, v123, s63
  s_waitcnt vmcnt(13)
  v_perm_b32 v123, v132, v128, s62
  v_perm_b32 v132, v132, v128, s63
  v_perm_b32 v128, v133, v129, s62
  v_perm_b32 v133, v133, v129, s63
  v_perm_b32 v129, v134, v130, s62
  v_perm_b32 v134, v134, v130, s63
  v_perm_b32 v130, v135, v131, s62
  v_perm_b32 v135, v135, v131, s63
  s_waitcnt vmcnt(11)
  v_perm_b32 v131, v140, v136, s62
  v_perm_b32 v140, v140, v136, s63
  v_perm_b32 v136, v141, v137, s62
  v_perm_b32 v141, v141, v137, s63
  v_perm_b32 v137, v142, v138, s62
  v_perm_b32 v142, v142, v138, s63
  v_perm_b32 v138, v143, v139, s62
  v_perm_b32 v143, v143, v139, s63
  s_branch L_o_in_51
L_o_49:
  global_load_dwordx4 v[230:233], v9, s[46:47] offset:1152 sc1
  global_load_dwordx4 v[234:237], v9, s[46:47] offset:1168 sc1
  global_load_short_d16_hi v214, v2, s[36:37] offset:-2048 sc1
  global_load_short_d16_hi v215, v2, s[36:37] offset:-1792 sc1
  global_load_short_d16_hi v216, v2, s[36:37] offset:-1536 sc1
  global_load_short_d16_hi v217, v2, s[36:37] offset:-1280 sc1
  global_load_short_d16_hi v218, v2, s[36:37] offset:-1024 sc1
  global_load_short_d16_hi v219, v2, s[36:37] offset:-768 sc1
  global_load_short_d16_hi v220, v2, s[36:37] offset:-512 sc1
  global_load_short_d16_hi v221, v2, s[36:37] offset:-256 sc1
L_o_in_51:
  s_sub_u32 s58, s58, 1
  s_cbranch_scc1 L_o_over_50
  s_waitcnt vmcnt(4)
  v_pk_add_f32 v[20:21], v[214:215], v[216:217]
  v_pk_add_f32 v[36:37], v[230:231], v[232:233]
  v_pk_add_f32 v[38:39], v[234:235], v[236:237]
  v_pk_add_f32 v[36:37], v[36:37], v[38:39]
  v_add_f32 v36, v36, v37
  s_waitcnt vmcnt(0)
  v_pk_add_f32 v[22:23], v[218:219], v[220:221]
  v_pk_add_f32 v[20:21], v[20:21], v[22:23]
  v_add_f32 v20, v20, v21
  v_cmp_u_f32 vcc, v20, v36
  v_or3_b32 v50, v230, v231, v232
  v_permlane32_swap_b32 v20, v36
  v_add_f32 v20, v20, v36
  v_mov_b32 v48, v20
  s_cbranch_vccnz L_o_49
  v_or3_b32 v50, v50, v233, v234
  v_permlane16_swap_b32 v20, v48
  v_add_f32 v20, v20, v48
  v_mov_b32 v36, v20
  v_or3_b32 v50, v50, v235, v236
  v_or_b32 v50, v50, v237
  v_permlane32_swap_b32 v20, v36
  v_rcp_f32 v36, v36
  v_cmp_gt_i32 vcc, 0, v50
  v_mul_f32 v20, v20, v36
  s_nop 1
  v_mov_b32_dpp v48, v20 quad_perm:[1,0,3,2] row_mask:0xf bank_mask:0xf
  v_cvt_pk_bf16_f32 v16, v20, v48
  s_cbranch_vccnz L_ogen_48
L_onorm_47:
  global_store_dwordx4 v15, v[72:75], s[36:37] offset:-2048
  v_readlane_b32 s4, v16, 0
  v_readlane_b32 s5, v16, 2
  v_readlane_b32 s6, v16, 4
  v_dot2c_f32_bf16 v40, s4, v171
  v_dot2c_f32_bf16 v41, s4, v84
  v_readlane_b32 s7, v16, 6
  v_dot2c_f32_bf16 v42, s4, v80
  v_dot2c_f32_bf16 v43, s4, v85
  v_dot2c_f32_bf16 v44, s4, v81
  v_dot2c_f32_bf16 v45, s4, v86
  v_dot2c_f32_bf16 v46, s4, v82
  v_dot2c_f32_bf16 v47, s4, v87
  v_dot2c_f32_bf16 v40, s5, v83
  v_dot2c_f32_bf16 v41, s5, v92
  v_readlane_b32 s8, v16, 8
  v_dot2c_f32_bf16 v42, s5, v88
  v_dot2c_f32_bf16 v43, s5, v93
  v_dot2c_f32_bf16 v44, s5, v89
  v_dot2c_f32_bf16 v45, s5, v94
  v_dot2c_f32_bf16 v46, s5, v90
  v_dot2c_f32_bf16 v47, s5, v95
  v_dot2c_f32_bf16 v40, s6, v91
  v_dot2c_f32_bf16 v41, s6, v100
  v_readlane_b32 s9, v16, 10
  v_dot2c_f32_bf16 v42, s6, v96
  v_dot2c_f32_bf16 v43, s6, v101
  v_dot2c_f32_bf16 v44, s6, v97
  v_dot2c_f32_bf16 v45, s6, v102
  v_dot2c_f32_bf16 v46, s6, v98
  v_dot2c_f32_bf16 v47, s6, v103
  v_dot2c_f32_bf16 v40, s7, v99
  v_dot2c_f32_bf16 v41, s7, v108
  v_readlane_b32 s10, v16, 12
  v_dot2c_f32_bf16 v42, s7, v104
  v_dot2c_f32_bf16 v43, s7, v109
  v_dot2c_f32_bf16 v44, s7, v105
  v_dot2c_f32_bf16 v45, s7, v110
  v_dot2c_f32_bf16 v46, s7, v106
  v_dot2c_f32_bf16 v47, s7, v111
  v_dot2c_f32_bf16 v40, s8, v107
  v_dot2c_f32_bf16 v41, s8, v116
  v_readlane_b32 s11, v16, 14
  v_dot2c_f32_bf16 v42, s8, v112
  v_dot2c_f32_bf16 v43, s8, v117
  v_dot2c_f32_bf16 v44, s8, v113
  v_dot2c_f32_bf16 v45, s8, v118
  v_dot2c_f32_bf16 v46, s8, v114
  v_dot2c_f32_bf16 v47, s8, v119
  v_dot2c_f32_bf16 v40, s9, v115
  v_dot2c_f32_bf16 v41, s9, v124
  v_dot2c_f32_bf16 v42, s9, v120
  v_dot2c_f32_bf16 v43, s9, v125
  v_dot2c_f32_bf16 v44, s9, v121
  v_dot2c_f32_bf16 v45, s9, v126
  v_dot2c_f32_bf16 v46, s9, v122
  v_dot2c_f32_bf16 v47, s9, v127
  v_dot2c_f32_bf16 v40, s10, v123
  v_dot2c_f32_bf16 v41, s10, v132
  v_dot2c_f32_bf16 v42, s10, v128
  v_dot2c_f32_bf16 v43, s10, v133
  v_dot2c_f32_bf16 v44, s10, v129
  v_dot2c_f32_bf16 v45, s10, v134
  v_dot2c_f32_bf16 v46, s10, v130
  v_dot2c_f32_bf16 v47, s10, v135
  v_dot2c_f32_bf16 v40, s11, v131
  v_dot2c_f32_bf16 v41, s11, v140
  v_dot2c_f32_bf16 v42, s11, v136
  v_dot2c_f32_bf16 v43, s11, v141
  v_dot2c_f32_bf16 v44, s11, v137
  v_dot2c_f32_bf16 v45, s11, v142
  v_dot2c_f32_bf16 v46, s11, v138
  v_dot2c_f32_bf16 v47, s11, v143
  v_cvt_pk_bf16_f32 v48, v40, v41
  v_cvt_pk_bf16_f32 v49, v42, v43
  v_cvt_pk_bf16_f32 v50, v44, v45
  v_cvt_pk_bf16_f32 v51, v46, v47
  s_waitcnt vmcnt(0)
  global_store_dwordx4 v3, v[48:51], s[36:37] offset:0
  s_barrier
  s_nop 0
  v_and_b32 v49, 0xffff, v250
  v_cmp_eq_u32 vcc, s25, v49
  v_ashrrev_i32 v48, 16, v250
  s_nop 0
  v_cndmask_b32 v48, 0, v48, vcc
  s_nop 1
  v_add_u32_dpp v48, v48, v48 row_ror:8 row_mask:0xf bank_mask:0xf
  s_nop 1
  v_add_u32_dpp v48, v48, v48 row_ror:4 row_mask:0xf bank_mask:0xf
  s_nop 1
  v_add_u32_dpp v48, v48, v48 row_ror:2 row_mask:0xf bank_mask:0xf
  s_nop 1
  v_add_u32_dpp v48, v48, v48 row_ror:1 row_mask:0xf bank_mask:0xf
  v_mov_b32 v49, v48
  s_nop 1
  v_permlane16_swap_b32 v48, v49
  v_add_u32 v48, v48, v49
  s_ashr_i32 s30, s24, 16
  v_add_u32 v48, s30, v48
  ds_write_b32 v76, v48 offset:41104
  s_cmp_lt_u32 s29, 28
  s_cbranch_scc0 L_nocg_55
  s_sleep 7
  s_mov_b32 s65, 2000
  s_mov_b32 s58, 64
L_cs_57:
  global_load_short_d16_hi v214, v2, s[36:37] offset:2048 sc1
  global_load_short_d16_hi v215, v2, s[36:37] offset:2304 sc1
  global_load_short_d16_hi v216, v2, s[36:37] offset:2560 sc1
  global_load_short_d16_hi v217, v2, s[36:37] offset:2816 sc1
  global_load_short_d16_hi v218, v2, s[36:37] offset:3072 sc1
  global_load_short_d16_hi v219, v2, s[36:37] offset:3328 sc1
  global_load_short_d16_hi v220, v2, s[36:37] offset:3584 sc1
  global_load_short_d16_hi v221, v2, s[36:37] offset:3840 sc1
  s_sub_u32 s58, s58, 1
  s_cbranch_scc1 L_cs_over_58
  s_waitcnt vmcnt(4)
  v_pk_add_f32 v[20:21], v[214:215], v[216:217]
  s_waitcnt vmcnt(0)
  v_pk_add_f32 v[22:23], v[218:219], v[220:221]
  v_pk_add_f32 v[20:21], v[20:21], v[22:23]
  v_add_f32 v20, v20, v21
  v_mov_b32 v48, v20
  v_cmp_u_f32 vcc, v20, v20
  s_nop 0
  v_permlane32_swap_b32 v20, v48
  v_add_f32 v20, v20, v48
  v_mov_b32 v48, v20
  s_cbranch_vccnz L_cs_57
L_cs_done_56:
  s_nop 0
  v_permlane16_swap_b32 v20, v48
  v_add_f32 v20, v20, v48
  v_mov_b32 v14, v20
  global_store_dwordx4 v15, v[72:75], s[36:37] offset:2048
L_nocg_55:
  v_mov_b64 v[40:41], 0
  v_mov_b64 v[42:43], 0
  v_mov_b64 v[44:45], 0
  v_mov_b64 v[46:47], 0
  s_barrier
  s_cmp_lt_u32 s29, 28
  s_cbranch_scc0 L_noffn_54
  s_mov_b32 s65, 2000
  s_mov_b32 s58, 128000
  v_mov_b64 v[52:53], 0
  v_mov_b32 v54, 0x3b000000
  v_mov_b32 v55, 0x3727c5ac
  s_sleep 5
  global_load_dwordx4 v[238:241], v8, s[46:47] offset:-2048 sc1
  s_nop 15
  s_nop 0
  global_load_dwordx4 v[238:241], v8, s[46:47] offset:-2048 sc1
  s_nop 15
  s_nop 0
  global_load_dwordx4 v[238:241], v8, s[46:47] offset:-2048 sc1
  s_waitcnt vmcnt(2)
  v_max3_u32 v48, v238, v239, v240
  v_max_u32 v48, v48, v241
  v_cmp_eq_u32 vcc, -1, v48
  s_cbranch_vccz L_xok_61
  s_waitcnt vmcnt(1)
  v_max3_u32 v48, v238, v239, v240
  v_max_u32 v48, v48, v241
  v_cmp_eq_u32 vcc, -1, v48
  s_cbranch_vccz L_xok_61
  s_waitcnt vmcnt(0)
  v_max3_u32 v48, v238, v239, v240
  v_max_u32 v48, v48, v241
  v_cmp_eq_u32 vcc, -1, v48
  s_cbranch_vccnz L_xretry_60
L_xok_61:
  v_dot2c_f32_bf16 v52, s64, v238
  v_dot2c_f32_bf16 v53, v238, v238
  v_dot2c_f32_bf16 v52, s64, v239
  v_dot2c_f32_bf16 v53, v239, v239
  v_dot2c_f32_bf16 v52, s64, v240
  v_dot2c_f32_bf16 v53, v240, v240
  v_dot2c_f32_bf16 v52, s64, v241
  v_dot2c_f32_bf16 v53, v241, v241
  global_load_short_d16_hi v214, v2, s[36:37] offset:-2048 sc1
  global_load_short_d16_hi v215, v2, s[36:37] offset:-1792 sc1
  global_load_short_d16_hi v216, v2, s[36:37] offset:-1536 sc1
  v_permlane32_swap_b32 v52, v53
  v_add_f32 v52, v52, v53
  v_mov_b32 v53, v52
  global_load_short_d16_hi v217, v2, s[36:37] offset:-1280 sc1
  global_load_short_d16_hi v218, v2, s[36:37] offset:-1024 sc1
  v_permlane16_swap_b32 v52, v53
  v_add_f32 v52, v52, v53
  global_load_short_d16_hi v219, v2, s[36:37] offset:-768 sc1
  global_load_short_d16_hi v220, v2, s[36:37] offset:-512 sc1
  v_add_f32_dpp v52, v52, v52 row_ror:8 row_mask:0xf bank_mask:0xf
  global_load_short_d16_hi v221, v2, s[36:37] offset:-256 sc1
  global_load_short_d16_hi v214, v2, s[36:37] offset:-2048 sc1
  v_add_f32_dpp v52, v52, v52 row_ror:4 row_mask:0xf bank_mask:0xf
  global_load_short_d16_hi v215, v2, s[36:37] offset:-1792 sc1
  global_load_short_d16_hi v216, v2, s[36:37] offset:-1536 sc1
  v_add_f32_dpp v52, v52, v52 row_ror:2 row_mask:0xf bank_mask:0xf
  global_load_short_d16_hi v217, v2, s[36:37] offset:-1280 sc1
  global_load_short_d16_hi v218, v2, s[36:37] offset:-1024 sc1
  v_add_f32_dpp v52, v52, v52 row_ror:1 row_mask:0xf bank_mask:0xf
  global_load_short_d16_hi v219, v2, s[36:37] offset:-768 sc1
  v_readlane_b32 s30, v52, 0
  v_readlane_b32 s31, v52, 32
  global_load_short_d16_hi v220, v2, s[36:37] offset:-512 sc1
  v_mul_f32 v17, s30, v54
  v_fma_f32 v18, s31, v54, v55
  v_fma_f32 v18, -v17, v17, v18
  v_max_f32 v18, v18, v55
  v_rsq_f32 v18, v18
  global_load_short_d16_hi v221, v2, s[36:37] offset:-256 sc1
  s_mov_b32 s58, 64
  v_mul_f32 v19, v17, v18
  v_mul_f32_e64 v19, -v19, v14
L_gu_62_c:
  s_waitcnt vmcnt(12)
  v_pk_add_f32 v[20:21], v[214:215], v[216:217]
  s_waitcnt vmcnt(8)
  v_pk_add_f32 v[22:23], v[218:219], v[220:221]
  v_pk_add_f32 v[20:21], v[20:21], v[22:23]
  v_add_f32 v20, v20, v21
  v_mov_b32 v48, v20
  v_cmp_u_f32 vcc, v20, v20
  s_nop 0
  v_permlane32_swap_b32 v20, v48
  v_add_f32 v20, v20, v48
  v_mov_b32 v48, v20
  s_cbranch_vccnz L_gu_62
L_gu_done_59:
  s_nop 0
  v_permlane16_swap_b32 v20, v48
  v_add_f32 v20, v20, v48
  global_store_dwordx4 v15, v[72:75], s[36:37] offset:-2048
  v_fma_f32 v20, v20, v18, v19
  s_nop 1
  v_mul_f32_dpp v20, v20, v20 row_ror:8 row_mask:0xf bank_mask:0xf
  s_nop 1
  v_mov_b32_dpp v48, v20 quad_perm:[1,0,3,2] row_mask:0xf bank_mask:0xf
  v_cvt_pk_bf16_f32 v16, v20, v48
  s_nop 0
  v_readlane_b32 s4, v16, 0
  v_readlane_b32 s5, v16, 2
  v_readlane_b32 s6, v16, 4
  v_dot2c_f32_bf16 v40, s4, v212
  v_dot2c_f32_bf16 v41, s4, v148
  v_readlane_b32 s7, v16, 6
  v_dot2c_f32_bf16 v42, s4, v144
  v_dot2c_f32_bf16 v43, s4, v149
  v_dot2c_f32_bf16 v44, s4, v145
  v_dot2c_f32_bf16 v45, s4, v150
  v_dot2c_f32_bf16 v46, s4, v146
  v_dot2c_f32_bf16 v47, s4, v151
  v_dot2c_f32_bf16 v40, s5, v147
  v_dot2c_f32_bf16 v41, s5, v156
  v_dot2c_f32_bf16 v42, s5, v152
  v_dot2c_f32_bf16 v43, s5, v157
  v_dot2c_f32_bf16 v44, s5, v153
  v_dot2c_f32_bf16 v45, s5, v158
  v_dot2c_f32_bf16 v46, s5, v154
  v_dot2c_f32_bf16 v47, s5, v159
  v_dot2c_f32_bf16 v40, s6, v155
  v_dot2c_f32_bf16 v41, s6, v164
  v_dot2c_f32_bf16 v42, s6, v160
  v_dot2c_f32_bf16 v43, s6, v165
  v_dot2c_f32_bf16 v44, s6, v161
  v_dot2c_f32_bf16 v45, s6, v166
  v_dot2c_f32_bf16 v46, s6, v162
  v_dot2c_f32_bf16 v47, s6, v167
  v_dot2c_f32_bf16 v40, s7, v163
  v_dot2c_f32_bf16 v41, s7, v172
  v_dot2c_f32_bf16 v42, s7, v168
  v_dot2c_f32_bf16 v43, s7, v173
  v_dot2c_f32_bf16 v44, s7, v169
  v_dot2c_f32_bf16 v45, s7, v174
  v_dot2c_f32_bf16 v46, s7, v170
  v_dot2c_f32_bf16 v47, s7, v175
  v_cvt_pk_bf16_f32 v48, v40, v41
  v_cvt_pk_bf16_f32 v49, v42, v43
  v_cvt_pk_bf16_f32 v50, v44, v45
  v_cvt_pk_bf16_f32 v51, v46, v47
  s_waitcnt vmcnt(0)
  global_store_dwordx4 v3, v[48:51], s[36:37] offset:0
L_noffn_54:
  s_barrier
  s_barrier
  s_barrier
  s_barrier
  v_mov_b64 v[40:41], 0
  v_mov_b64 v[42:43], 0
  v_mov_b64 v[44:45], 0
  v_mov_b64 v[46:47], 0
  s_mov_b32 s65, 2000
  s_mov_b32 s58, 64
  s_nop 15
  s_nop 3
  global_load_dwordx4 v[230:233], v9, s[46:47] offset:2176 sc1
  global_load_dwordx4 v[234:237], v9, s[46:47] offset:2192 sc1
  global_load_short_d16_hi v214, v2, s[36:37] offset:0 sc1
  global_load_short_d16_hi v215, v2, s[36:37] offset:256 sc1
  global_load_short_d16_hi v216, v2, s[36:37] offset:512 sc1
  global_load_short_d16_hi v217, v2, s[36:37] offset:768 sc1
  global_load_short_d16_hi v218, v2, s[36:37] offset:1024 sc1
  global_load_short_d16_hi v219, v2, s[36:37] offset:1280 sc1
  global_load_short_d16_hi v220, v2, s[36:37] offset:1536 sc1
  global_load_short_d16_hi v221, v2, s[36:37] offset:1792 sc1
  s_nop 14
  global_load_dwordx4 v[230:233], v9, s[46:47] offset:2176 sc1
  global_load_dwordx4 v[234:237], v9, s[46:47] offset:2192 sc1
  global_load_short_d16_hi v214, v2, s[36:37] offset:0 sc1
  global_load_short_d16_hi v215, v2, s[36:37] offset:256 sc1
  global_load_short_d16_hi v216, v2, s[36:37] offset:512 sc1
  global_load_short_d16_hi v217, v2, s[36:37] offset:768 sc1
  global_load_short_d16_hi v218, v2, s[36:37] offset:1024 sc1
  global_load_short_d16_hi v219, v2, s[36:37] offset:1280 sc1
  global_load_short_d16_hi v220, v2, s[36:37] offset:1536 sc1
  global_load_short_d16_hi v221, v2, s[36:37] offset:1792 sc1
  s_nop 14
L_o_66:
  global_load_dwordx4 v[230:233], v9, s[46:47] offset:2176 sc1
  global_load_dwordx4 v[234:237], v9, s[46:47] offset:2192 sc1
  global_load_short_d16_hi v214, v2, s[36:37] offset:0 sc1
  global_load_short_d16_hi v215, v2, s[36:37] offset:256 sc1
  global_load_short_d16_hi v216, v2, s[36:37] offset:512 sc1
  global_load_short_d16_hi v217, v2, s[36:37] offset:768 sc1
  global_load_short_d16_hi v218, v2, s[36:37] offset:1024 sc1
  global_load_short_d16_hi v219, v2, s[36:37] offset:1280 sc1
  global_load_short_d16_hi v220, v2, s[36:37] offset:1536 sc1
  global_load_short_d16_hi v221, v2, s[36:37] offset:1792 sc1
  s_sub_u32 s58, s58, 1
  s_cbranch_scc1 L_o_over_67
  s_waitcnt vmcnt(24)
  v_pk_add_f32 v[20:21], v[214:215], v[216:217]
  v_pk_add_f32 v[36:37], v[230:231], v[232:233]
  v_pk_add_f32 v[38:39], v[234:235], v[236:237]
  v_pk_add_f32 v[36:37], v[36:37], v[38:39]
  v_add_f32 v36, v36, v37
  s_waitcnt vmcnt(20)
  v_pk_add_f32 v[22:23], v[218:219], v[220:221]
  v_pk_add_f32 v[20:21], v[20:21], v[22:23]
  v_add_f32 v20, v20, v21
  v_cmp_u_f32 vcc, v20, v36
  v_or3_b32 v50, v230, v231, v232
  v_permlane32_swap_b32 v20, v36
  v_add_f32 v20, v20, v36
  v_mov_b32 v48, v20
  s_cbranch_vccnz L_o_66
  v_or3_b32 v50, v50, v233, v234
  v_permlane16_swap_b32 v20, v48
  v_add_f32 v20, v20, v48
  v_mov_b32 v36, v20
  v_or3_b32 v50, v50, v235, v236
  v_or_b32 v50, v50, v237
  v_permlane32_swap_b32 v20, v36
  v_rcp_f32 v36, v36
  v_cmp_gt_i32 vcc, 0, v50
  v_mul_f32 v20, v20, v36
  s_nop 1
  v_mov_b32_dpp v48, v20 quad_perm:[1,0,3,2] row_mask:0xf bank_mask:0xf
  v_cvt_pk_bf16_f32 v16, v20, v48
  s_cbranch_vccnz L_ogen_65
L_onorm_64:
  global_store_dwordx4 v15, v[72:75], s[36:37] offset:0
  v_readlane_b32 s4, v16, 0
  v_readlane_b32 s5, v16, 2
  v_readlane_b32 s6, v16, 4
  v_dot2c_f32_bf16 v40, s4, v171
  v_dot2c_f32_bf16 v41, s4, v84
  v_readlane_b32 s7, v16, 6
  v_dot2c_f32_bf16 v42, s4, v80
  v_dot2c_f32_bf16 v43, s4, v85
  v_dot2c_f32_bf16 v44, s4, v81
  v_dot2c_f32_bf16 v45, s4, v86
  v_dot2c_f32_bf16 v46, s4, v82
  v_dot2c_f32_bf16 v47, s4, v87
  v_dot2c_f32_bf16 v40, s5, v83
  v_dot2c_f32_bf16 v41, s5, v92
  v_readlane_b32 s8, v16, 8
  v_dot2c_f32_bf16 v42, s5, v88
  v_dot2c_f32_bf16 v43, s5, v93
  v_dot2c_f32_bf16 v44, s5, v89
  v_dot2c_f32_bf16 v45, s5, v94
  v_dot2c_f32_bf16 v46, s5, v90
  v_dot2c_f32_bf16 v47, s5, v95
  v_dot2c_f32_bf16 v40, s6, v91
  v_dot2c_f32_bf16 v41, s6, v100
  v_readlane_b32 s9, v16, 10
  v_dot2c_f32_bf16 v42, s6, v96
  v_dot2c_f32_bf16 v43, s6, v101
  v_dot2c_f32_bf16 v44, s6, v97
  v_dot2c_f32_bf16 v45, s6, v102
  v_dot2c_f32_bf16 v46, s6, v98
  v_dot2c_f32_bf16 v47, s6, v103
  v_dot2c_f32_bf16 v40, s7, v99
  v_dot2c_f32_bf16 v41, s7, v108
  v_readlane_b32 s10, v16, 12
  v_dot2c_f32_bf16 v42, s7, v104
  v_dot2c_f32_bf16 v43, s7, v109
  v_dot2c_f32_bf16 v44, s7, v105
  v_dot2c_f32_bf16 v45, s7, v110
  v_dot2c_f32_bf16 v46, s7, v106
  v_dot2c_f32_bf16 v47, s7, v111
  v_dot2c_f32_bf16 v40, s8, v107
  v_dot2c_f32_bf16 v41, s8, v116
  v_readlane_b32 s11, v16, 14
  v_dot2c_f32_bf16 v42, s8, v112
  v_dot2c_f32_bf16 v43, s8, v117
  v_dot2c_f32_bf16 v44, s8, v113
  v_dot2c_f32_bf16 v45, s8, v118
  v_dot2c_f32_bf16 v46, s8, v114
  v_dot2c_f32_bf16 v47, s8, v119
  v_dot2c_f32_bf16 v40, s9, v115
  v_dot2c_f32_bf16 v41, s9, v124
  v_dot2c_f32_bf16 v42, s9, v120
  v_dot2c_f32_bf16 v43, s9, v125
  v_dot2c_f32_bf16 v44, s9, v121
  v_dot2c_f32_bf16 v45, s9, v126
  v_dot2c_f32_bf16 v46, s9, v122
  v_dot2c_f32_bf16 v47, s9, v127
  v_dot2c_f32_bf16 v40, s10, v123
  v_dot2c_f32_bf16 v41, s10, v132
  v_dot2c_f32_bf16 v42, s10, v128
  v_dot2c_f32_bf16 v43, s10, v133
  v_dot2c_f32_bf16 v44, s10, v129
  v_dot2c_f32_bf16 v45, s10, v134
  v_dot2c_f32_bf16 v46, s10, v130
  v_dot2c_f32_bf16 v47, s10, v135
  v_dot2c_f32_bf16 v40, s11, v131
  v_dot2c_f32_bf16 v41, s11, v140
  v_dot2c_f32_bf16 v42, s11, v136
  v_dot2c_f32_bf16 v43, s11, v141
  v_dot2c_f32_bf16 v44, s11, v137
  v_dot2c_f32_bf16 v45, s11, v142
  v_dot2c_f32_bf16 v46, s11, v138
  v_dot2c_f32_bf16 v47, s11, v143
  v_cvt_pk_bf16_f32 v48, v40, v41
  v_cvt_pk_bf16_f32 v49, v42, v43
  v_cvt_pk_bf16_f32 v50, v44, v45
  v_cvt_pk_bf16_f32 v51, v46, v47
  s_waitcnt vmcnt(0)
  global_store_dwordx4 v3, v[48:51], s[36:37] offset:-2048
  s_barrier
  v_mov_b64 v[40:41], 0
  v_mov_b64 v[42:43], 0
  v_mov_b64 v[44:45], 0
  v_mov_b64 v[46:47], 0
  s_barrier
  s_cmp_lt_u32 s29, 28
  s_cbranch_scc0 L_noffn_69
  s_mov_b32 s65, 2000
  s_mov_b32 s58, 128000
  v_mov_b64 v[52:53], 0
  v_mov_b32 v54, 0x3b000000
  v_mov_b32 v55, 0x3727c5ac
  s_sleep 5
  global_load_dwordx4 v[238:241], v8, s[46:47] offset:0 sc1
  s_nop 15
  s_nop 0
  global_load_dwordx4 v[238:241], v8, s[46:47] offset:0 sc1
  s_nop 15
  s_nop 0
  global_load_dwordx4 v[238:241], v8, s[46:47] offset:0 sc1
  s_waitcnt vmcnt(2)
  v_max3_u32 v48, v238, v239, v240
  v_max_u32 v48, v48, v241
  v_cmp_eq_u32 vcc, -1, v48
  s_cbranch_vccz L_xok_72
  s_waitcnt vmcnt(1)
  v_max3_u32 v48, v238, v239, v240
  v_max_u32 v48, v48, v241
  v_cmp_eq_u32 vcc, -1, v48
  s_cbranch_vccz L_xok_72
  s_waitcnt vmcnt(0)
  v_max3_u32 v48, v238, v239, v240
  v_max_u32 v48, v48, v241
  v_cmp_eq_u32 vcc, -1, v48
  s_cbranch_vccnz L_xretry_71
L_xok_72:
  v_dot2c_f32_bf16 v52, s64, v238
  v_dot2c_f32_bf16 v53, v238, v238
  v_dot2c_f32_bf16 v52, s64, v239
  v_dot2c_f32_bf16 v53, v239, v239
  v_dot2c_f32_bf16 v52, s64, v240
  v_dot2c_f32_bf16 v53, v240, v240
  v_dot2c_f32_bf16 v52, s64, v241
  v_dot2c_f32_bf16 v53, v241, v241
  global_load_short_d16_hi v214, v2, s[36:37] offset:0 sc1
  global_load_short_d16_hi v215, v2, s[36:37] offset:256 sc1
  global_load_short_d16_hi v216, v2, s[36:37] offset:512 sc1
  v_permlane32_swap_b32 v52, v53
  v_add_f32 v52, v52, v53
  v_mov_b32 v53, v52
  global_load_short_d16_hi v217, v2, s[36:37] offset:768 sc1
  global_load_short_d16_hi v218, v2, s[36:37] offset:1024 sc1
  v_permlane16_swap_b32 v52, v53
  v_add_f32 v52, v52, v53
  global_load_short_d16_hi v219, v2, s[36:37] offset:1280 sc1
  global_load_short_d16_hi v220, v2, s[36:37] offset:1536 sc1
  v_add_f32_dpp v52, v52, v52 row_ror:8 row_mask:0xf bank_mask:0xf
  global_load_short_d16_hi v221, v2, s[36:37] offset:1792 sc1
  global_load_short_d16_hi v214, v2, s[36:37] offset:0 sc1
  v_add_f32_dpp v52, v52, v52 row_ror:4 row_mask:0xf bank_mask:0xf
  global_load_short_d16_hi v215, v2, s[36:37] offset:256 sc1
  global_load_short_d16_hi v216, v2, s[36:37] offset:512 sc1
  v_add_f32_dpp v52, v52, v52 row_ror:2 row_mask:0xf bank_mask:0xf
  global_load_short_d16_hi v217, v2, s[36:37] offset:768 sc1
  global_load_short_d16_hi v218, v2, s[36:37] offset:1024 sc1
  v_add_f32_dpp v52, v52, v52 row_ror:1 row_mask:0xf bank_mask:0xf
  global_load_short_d16_hi v219, v2, s[36:37] offset:1280 sc1
  v_readlane_b32 s30, v52, 0
  v_readlane_b32 s31, v52, 32
  global_load_short_d16_hi v220, v2, s[36:37] offset:1536 sc1
  v_mul_f32 v17, s30, v54
  v_fma_f32 v18, s31, v54, v55
  v_fma_f32 v18, -v17, v17, v18
  v_max_f32 v18, v18, v55
  v_rsq_f32 v18, v18
  global_load_short_d16_hi v221, v2, s[36:37] offset:1792 sc1
  s_mov_b32 s58, 64
  v_mul_f32 v19, v17, v18
  v_mul_f32_e64 v19, -v19, v14
L_gu_73_c:
  s_waitcnt vmcnt(12)
  v_pk_add_f32 v[20:21], v[214:215], v[216:217]
  s_waitcnt vmcnt(8)
  v_pk_add_f32 v[22:23], v[218:219], v[220:221]
  v_pk_add_f32 v[20:21], v[20:21], v[22:23]
  v_add_f32 v20, v20, v21
  v_mov_b32 v48, v20
  v_cmp_u_f32 vcc, v20, v20
  s_nop 0
  v_permlane32_swap_b32 v20, v48
  v_add_f32 v20, v20, v48
  v_mov_b32 v48, v20
  s_cbranch_vccnz L_gu_73
L_gu_done_70:
  s_nop 0
  v_permlane16_swap_b32 v20, v48
  v_add_f32 v20, v20, v48
  v_fma_f32 v20, v20, v18, v19
  s_nop 1
  v_mul_f32_dpp v20, v20, v20 row_ror:8 row_mask:0xf bank_mask:0xf
  s_nop 1
  v_mov_b32_dpp v48, v20 quad_perm:[1,0,3,2] row_mask:0xf bank_mask:0xf
  v_cvt_pk_bf16_f32 v16, v20, v48
  s_nop 0
  v_readlane_b32 s4, v16, 0
  v_readlane_b32 s5, v16, 2
  v_readlane_b32 s6, v16, 4
  v_dot2c_f32_bf16 v40, s4, v212
  v_dot2c_f32_bf16 v41, s4, v148
  v_readlane_b32 s7, v16, 6
  v_dot2c_f32_bf16 v42, s4, v144
  v_dot2c_f32_bf16 v43, s4, v149
  v_dot2c_f32_bf16 v44, s4, v145
  v_dot2c_f32_bf16 v45, s4, v150
  v_dot2c_f32_bf16 v46, s4, v146
  v_dot2c_f32_bf16 v47, s4, v151
  v_dot2c_f32_bf16 v40, s5, v147
  v_dot2c_f32_bf16 v41, s5, v156
  v_dot2c_f32_bf16 v42, s5, v152
  v_dot2c_f32_bf16 v43, s5, v157
  v_dot2c_f32_bf16 v44, s5, v153
  v_dot2c_f32_bf16 v45, s5, v158
  v_dot2c_f32_bf16 v46, s5, v154
  v_dot2c_f32_bf16 v47, s5, v159
  v_dot2c_f32_bf16 v40, s6, v155
  v_dot2c_f32_bf16 v41, s6, v164
  v_dot2c_f32_bf16 v42, s6, v160
  v_dot2c_f32_bf16 v43, s6, v165
  v_dot2c_f32_bf16 v44, s6, v161
  v_dot2c_f32_bf16 v45, s6, v166
  v_dot2c_f32_bf16 v46, s6, v162
  v_dot2c_f32_bf16 v47, s6, v167
  v_dot2c_f32_bf16 v40, s7, v163
  v_dot2c_f32_bf16 v41, s7, v172
  v_dot2c_f32_bf16 v42, s7, v168
  v_dot2c_f32_bf16 v43, s7, v173
  v_dot2c_f32_bf16 v44, s7, v169
  v_dot2c_f32_bf16 v45, s7, v174
  v_dot2c_f32_bf16 v46, s7, v170
  v_dot2c_f32_bf16 v47, s7, v175
  v_cvt_pk_bf16_f32 v48, v40, v41
  v_cvt_pk_bf16_f32 v49, v42, v43
  v_cvt_pk_bf16_f32 v50, v44, v45
  v_cvt_pk_bf16_f32 v51, v46, v47
  global_store_dwordx4 v3, v[48:51], s[36:37] offset:-2048
L_noffn_69:
  s_barrier
  s_endpgm
L_o_over_50:
  s_sub_u32 s65, s65, 1
  s_cbranch_scc1 L_exit
  s_mov_b32 s58, 64
  s_waitcnt vmcnt(0)
  v_max3_u32 v48, v214, v215, v216
  v_max3_u32 v48, v48, v217, v218
  v_max3_u32 v48, v48, v219, v220
  v_max3_u32 v48, v48, v221, v221
  v_cmp_eq_u32 vcc, 0xffff0000, v48
  s_cbranch_vccnz L_o_49
  v_max3_u32 v48, v230, v231, v232
  v_max3_u32 v48, v48, v233, v234
  v_max3_u32 v48, v48, v235, v236
  v_max3_u32 v48, v48, v237, v237
  v_cmp_eq_u32 vcc, -1, v48
  s_cbranch_vccnz L_o_49
  s_branch L_ogen_48
L_ogen_48:
  s_waitcnt vmcnt(0)
  s_mov_b32 s58, 128000
L_omloop_53:
  s_sub_u32 s58, s58, 1
  s_cbranch_scc1 L_exit
  global_load_dwordx4 v[222:225], v9, s[46:47] offset:1024 sc1
  global_load_dwordx4 v[226:229], v9, s[46:47] offset:1040 sc1
  s_waitcnt vmcnt(0)
  v_cmp_gt_i32 vcc, 0, v230
  s_nop 1
  v_cndmask_b32 v64, 0, v222, vcc
  v_cmp_gt_i32 vcc, 0, v231
  s_nop 1
  v_cndmask_b32 v65, 0, v223, vcc
  v_cmp_gt_i32 vcc, 0, v232
  s_nop 1
  v_cndmask_b32 v66, 0, v224, vcc
  v_cmp_gt_i32 vcc, 0, v233
  s_nop 1
  v_cndmask_b32 v67, 0, v225, vcc
  v_cmp_gt_i32 vcc, 0, v234
  s_nop 1
  v_cndmask_b32 v68, 0, v226, vcc
  v_cmp_gt_i32 vcc, 0, v235
  s_nop 1
  v_cndmask_b32 v69, 0, v227, vcc
  v_cmp_gt_i32 vcc, 0, v236
  s_nop 1
  v_cndmask_b32 v70, 0, v228, vcc
  v_cmp_gt_i32 vcc, 0, v237
  s_nop 1
  v_cndmask_b32 v71, 0, v229, vcc
  v_max3_u32 v48, v64, v65, v66
  v_max3_u32 v48, v48, v67, v68
  v_max3_u32 v48, v48, v69, v70
  v_max3_u32 v48, v48, v71, v71
  v_cmp_eq_u32 vcc, -1, v48
  s_cbranch_vccnz L_omloop_53
  v_max3_f32 v48, v64, v65, v66
  v_max3_f32 v48, v48, v67, v68
  v_max3_f32 v48, v48, v69, v70
  v_max_f32 v48, v48, v71
  v_mov_b32 v49, v48
  s_nop 1
  v_permlane32_swap_b32 v48, v49
  v_max_f32 v48, v48, v49
  v_mov_b32 v49, v48
  s_nop 1
  v_permlane16_swap_b32 v48, v49
  v_max_f32 v48, v48, v49
  v_sub_f32 v64, v64, v48
  v_sub_f32 v65, v65, v48
  v_sub_f32 v66, v66, v48
  v_sub_f32 v67, v67, v48
  v_sub_f32 v68, v68, v48
  v_sub_f32 v69, v69, v48
  v_sub_f32 v70, v70, v48
  v_sub_f32 v71, v71, v48
  v_exp_f32 v64, v64
  v_exp_f32 v65, v65
  v_exp_f32 v66, v66
  v_exp_f32 v67, v67
  v_exp_f32 v68, v68
  v_exp_f32 v69, v69
  v_exp_f32 v70, v70
  v_exp_f32 v71, v71
  v_mul_f32 v20, v64, v214
  v_mul_f32_e64 v36, v64, |v230|
  v_fmac_f32 v20, v65, v215
  v_fma_f32 v36, v65, |v231|, v36
  v_fmac_f32 v20, v66, v216
  v_fma_f32 v36, v66, |v232|, v36
  v_fmac_f32 v20, v67, v217
  v_fma_f32 v36, v67, |v233|, v36
  v_fmac_f32 v20, v68, v218
  v_fma_f32 v36, v68, |v234|, v36
  v_fmac_f32 v20, v69, v219
  v_fma_f32 v36, v69, |v235|, v36
  v_fmac_f32 v20, v70, v220
  v_fma_f32 v36, v70, |v236|, v36
  v_fmac_f32 v20, v71, v221
  v_fma_f32 v36, v71, |v237|, v36
  v_mov_b32 v49, v36
  s_nop 1
  v_permlane32_swap_b32 v36, v49
  v_add_f32 v36, v36, v49
  v_mov_b32 v49, v36
  s_nop 1
  v_permlane16_swap_b32 v36, v49
  v_add_f32 v36, v36, v49
  v_mov_b32 v50, v20
  s_nop 1
  v_permlane32_swap_b32 v20, v50
  v_add_f32 v20, v20, v50
  v_mov_b32 v50, v20
  s_nop 1
  v_permlane16_swap_b32 v20, v50
  v_add_f32 v20, v20, v50
  v_rcp_f32 v36, v36
  s_nop 0
  v_mul_f32 v20, v20, v36
  s_nop 1
  v_mov_b32_dpp v48, v20 quad_perm:[1,0,3,2] row_mask:0xf bank_mask:0xf
  v_cvt_pk_bf16_f32 v16, v20, v48
  s_nop 1
  s_branch L_onorm_47
L_cs_over_58:
  s_sub_u32 s65, s65, 1
  s_cbranch_scc1 L_exit
  s_mov_b32 s58, 64
  s_waitcnt vmcnt(0)
  v_max3_u32 v48, v214, v215, v216
  v_max3_u32 v48, v48, v217, v218
  v_max3_u32 v48, v48, v219, v220
  v_max3_u32 v48, v48, v221, v221
  v_cmp_eq_u32 vcc, 0xffff0000, v48
  s_cbranch_vccnz L_cs_57
  s_waitcnt vmcnt(4)
  v_pk_add_f32 v[20:21], v[214:215], v[216:217]
  s_waitcnt vmcnt(0)
  v_pk_add_f32 v[22:23], v[218:219], v[220:221]
  v_pk_add_f32 v[20:21], v[20:21], v[22:23]
  v_add_f32 v20, v20, v21
  v_mov_b32 v48, v20
  s_nop 1
  v_permlane32_swap_b32 v20, v48
  v_add_f32 v20, v20, v48
  v_mov_b32 v48, v20
  s_branch L_cs_done_56
L_xretry_60:
  global_load_dwordx4 v[238:241], v8, s[46:47] offset:-2048 sc1
  s_nop 15
L_xretry_60_b:
  global_load_dwordx4 v[238:241], v8, s[46:47] offset:-2048 sc1
  s_sub_u32 s58, s58, 1
  s_cbranch_scc1 L_exit
  s_waitcnt vmcnt(1)
  v_max3_u32 v48, v238, v239, v240
  v_max_u32 v48, v48, v241
  v_cmp_eq_u32 vcc, -1, v48
  s_cbranch_vccnz L_xretry_60_b
  s_branch L_xok_61
L_gu_62:
  global_load_short_d16_hi v214, v2, s[36:37] offset:-2048 sc1
  global_load_short_d16_hi v215, v2, s[36:37] offset:-1792 sc1
  global_load_short_d16_hi v216, v2, s[36:37] offset:-1536 sc1
  global_load_short_d16_hi v217, v2, s[36:37] offset:-1280 sc1
  global_load_short_d16_hi v218, v2, s[36:37] offset:-1024 sc1
  global_load_short_d16_hi v219, v2, s[36:37] offset:-768 sc1
  global_load_short_d16_hi v220, v2, s[36:37] offset:-512 sc1
  global_load_short_d16_hi v221, v2, s[36:37] offset:-256 sc1
  s_sub_u32 s58, s58, 1
  s_cbranch_scc0 L_gu_62_c
  s_branch L_gu_over_63
L_gu_over_63:
  s_sub_u32 s65, s65, 1
  s_cbranch_scc1 L_exit
  s_mov_b32 s58, 64
  s_waitcnt vmcnt(0)
  v_max3_u32 v48, v214, v215, v216
  v_max3_u32 v48, v48, v217, v218
  v_max3_u32 v48, v48, v219, v220
  v_max3_u32 v48, v48, v221, v221
  v_cmp_eq_u32 vcc, 0xffff0000, v48
  s_cbranch_vccnz L_gu_62
  s_waitcnt vmcnt(4)
  v_pk_add_f32 v[20:21], v[214:215], v[216:217]
  s_waitcnt vmcnt(0)
  v_pk_add_f32 v[22:23], v[218:219], v[220:221]
  v_pk_add_f32 v[20:21], v[20:21], v[22:23]
  v_add_f32 v20, v20, v21
  v_mov_b32 v48, v20
  s_nop 1
  v_permlane32_swap_b32 v20, v48
  v_add_f32 v20, v20, v48
  v_mov_b32 v48, v20
  s_branch L_gu_done_59
L_o_over_67:
  s_sub_u32 s65, s65, 1
  s_cbranch_scc1 L_exit
  s_mov_b32 s58, 64
  s_waitcnt vmcnt(0)
  v_max3_u32 v48, v214, v215, v216
  v_max3_u32 v48, v48, v217, v218
  v_max3_u32 v48, v48, v219, v220
  v_max3_u32 v48, v48, v221, v221
  v_cmp_eq_u32 vcc, 0xffff0000, v48
  s_cbranch_vccnz L_o_66
  v_max3_u32 v48, v230, v231, v232
  v_max3_u32 v48, v48, v233, v234
  v_max3_u32 v48, v48, v235, v236
  v_max3_u32 v48, v48, v237, v237
  v_cmp_eq_u32 vcc, -1, v48
  s_cbranch_vccnz L_o_66
  s_branch L_ogen_65
L_ogen_65:
  s_waitcnt vmcnt(0)
  s_mov_b32 s58, 128000
L_omloop_68:
  s_sub_u32 s58, s58, 1
  s_cbranch_scc1 L_exit
  global_load_dwordx4 v[222:225], v9, s[46:47] offset:2048 sc1
  global_load_dwordx4 v[226:229], v9, s[46:47] offset:2064 sc1
  s_waitcnt vmcnt(0)
  v_cmp_gt_i32 vcc, 0, v230
  s_nop 1
  v_cndmask_b32 v64, 0, v222, vcc
  v_cmp_gt_i32 vcc, 0, v231
  s_nop 1
  v_cndmask_b32 v65, 0, v223, vcc
  v_cmp_gt_i32 vcc, 0, v232
  s_nop 1
  v_cndmask_b32 v66, 0, v224, vcc
  v_cmp_gt_i32 vcc, 0, v233
  s_nop 1
  v_cndmask_b32 v67, 0, v225, vcc
  v_cmp_gt_i32 vcc, 0, v234
  s_nop 1
  v_cndmask_b32 v68, 0, v226, vcc
  v_cmp_gt_i32 vcc, 0, v235
  s_nop 1
  v_cndmask_b32 v69, 0, v227, vcc
  v_cmp_gt_i32 vcc, 0, v236
  s_nop 1
  v_cndmask_b32 v70, 0, v228, vcc
  v_cmp_gt_i32 vcc, 0, v237
  s_nop 1
  v_cndmask_b32 v71, 0, v229, vcc
  v_max3_u32 v48, v64, v65, v66
  v_max3_u32 v48, v48, v67, v68
  v_max3_u32 v48, v48, v69, v70
  v_max3_u32 v48, v48, v71, v71
  v_cmp_eq_u32 vcc, -1, v48
  s_cbranch_vccnz L_omloop_68
  v_max3_f32 v48, v64, v65, v66
  v_max3_f32 v48, v48, v67, v68
  v_max3_f32 v48, v48, v69, v70
  v_max_f32 v48, v48, v71
  v_mov_b32 v49, v48
  s_nop 1
  v_permlane32_swap_b32 v48, v49
  v_max_f32 v48, v48, v49
  v_mov_b32 v49, v48
  s_nop 1
  v_permlane16_swap_b32 v48, v49
  v_max_f32 v48, v48, v49
  v_sub_f32 v64, v64, v48
  v_sub_f32 v65, v65, v48
  v_sub_f32 v66, v66, v48
  v_sub_f32 v67, v67, v48
  v_sub_f32 v68, v68, v48
  v_sub_f32 v69, v69, v48
  v_sub_f32 v70, v70, v48
  v_sub_f32 v71, v71, v48
  v_exp_f32 v64, v64
  v_exp_f32 v65, v65
  v_exp_f32 v66, v66
  v_exp_f32 v67, v67
  v_exp_f32 v68, v68
  v_exp_f32 v69, v69
  v_exp_f32 v70, v70
  v_exp_f32 v71, v71
  v_mul_f32 v20, v64, v214
  v_mul_f32_e64 v36, v64, |v230|
  v_fmac_f32 v20, v65, v215
  v_fma_f32 v36, v65, |v231|, v36
  v_fmac_f32 v20, v66, v216
  v_fma_f32 v36, v66, |v232|, v36
  v_fmac_f32 v20, v67, v217
  v_fma_f32 v36, v67, |v233|, v36
  v_fmac_f32 v20, v68, v218
  v_fma_f32 v36, v68, |v234|, v36
  v_fmac_f32 v20, v69, v219
  v_fma_f32 v36, v69, |v235|, v36
  v_fmac_f32 v20, v70, v220
  v_fma_f32 v36, v70, |v236|, v36
  v_fmac_f32 v20, v71, v221
  v_fma_f32 v36, v71, |v237|, v36
  v_mov_b32 v49, v36
  s_nop 1
  v_permlane32_swap_b32 v36, v49
  v_add_f32 v36, v36, v49
  v_mov_b32 v49, v36
  s_nop 1
  v_permlane16_swap_b32 v36, v49
  v_add_f32 v36, v36, v49
  v_mov_b32 v50, v20
  s_nop 1
  v_permlane32_swap_b32 v20, v50
  v_add_f32 v20, v20, v50
  v_mov_b32 v50, v20
  s_nop 1
  v_permlane16_swap_b32 v20, v50
  v_add_f32 v20, v20, v50
  v_rcp_f32 v36, v36
  s_nop 0
  v_mul_f32 v20, v20, v36
  s_nop 1
  v_mov_b32_dpp v48, v20 quad_perm:[1,0,3,2] row_mask:0xf bank_mask:0xf
  v_cvt_pk_bf16_f32 v16, v20, v48
  s_nop 1
  s_branch L_onorm_64
L_xretry_71:
  global_load_dwordx4 v[238:241], v8, s[46:47] offset:0 sc1
  s_nop 15
L_xretry_71_b:
  global_load_dwordx4 v[238:241], v8, s[46:47] offset:0 sc1
  s_sub_u32 s58, s58, 1
  s_cbranch_scc1 L_exit
  s_waitcnt vmcnt(1)
  v_max3_u32 v48, v238, v239, v240
  v_max_u32 v48, v48, v241
  v_cmp_eq_u32 vcc, -1, v48
  s_cbranch_vccnz L_xretry_71_b
  s_branch L_xok_72
L_gu_73:
  global_load_short_d16_hi v214, v2, s[36:37] offset:0 sc1
  global_load_short_d16_hi v215, v2, s[36:37] offset:256 sc1
  global_load_short_d16_hi v216, v2, s[36:37] offset:512 sc1
  global_load_short_d16_hi v217, v2, s[36:37] offset:768 sc1
  global_load_short_d16_hi v218, v2, s[36:37] offset:1024 sc1
  global_load_short_d16_hi v219, v2, s[36:37] offset:1280 sc1
  global_load_short_d16_hi v220, v2, s[36:37] offset:1536 sc1
  global_load_short_d16_hi v221, v2, s[36:37] offset:1792 sc1
  s_sub_u32 s58, s58, 1
  s_cbranch_scc0 L_gu_73_c
  s_branch L_gu_over_74
L_gu_over_74:
  s_sub_u32 s65, s65, 1
  s_cbranch_scc1 L_exit
  s_mov_b32 s58, 64
  s_waitcnt vmcnt(0)
  v_max3_u32 v48, v214, v215, v216
  v_max3_u32 v48, v48, v217, v218
  v_max3_u32 v48, v48, v219, v220
  v_max3_u32 v48, v48, v221, v221
  v_cmp_eq_u32 vcc, 0xffff0000, v48
  s_cbranch_vccnz L_gu_73
  s_waitcnt vmcnt(4)
  v_pk_add_f32 v[20:21], v[214:215], v[216:217]
  s_waitcnt vmcnt(0)
  v_pk_add_f32 v[22:23], v[218:219], v[220:221]
  v_pk_add_f32 v[20:21], v[20:21], v[22:23]
  v_add_f32 v20, v20, v21
  v_mov_b32 v48, v20
  s_nop 1
  v_permlane32_swap_b32 v20, v48
  v_add_f32 v20, v20, v48
  v_mov_b32 v48, v20
  s_branch L_gu_done_70
L_S2:
  v_mov_b32 v196, 0
  s_waitcnt lgkmcnt(0)
  s_barrier
  ds_read_b128 v[112:115], v200
  ds_read_b128 v[116:119], v201
  ds_read_b128 v[120:123], v202
  ds_read_b128 v[124:127], v203
  ds_write_b32 v5, v196
  s_waitcnt lgkmcnt(4)
  v_mfma_f32_16x16x32_bf16 v[128:131], v[16:19], v[112:115], 0
  s_waitcnt lgkmcnt(3)
  v_mfma_f32_16x16x32_bf16 v[128:131], v[20:23], v[116:119], v[128:131]
  s_waitcnt lgkmcnt(2)
  v_mfma_f32_16x16x32_bf16 v[128:131], v[24:27], v[120:123], v[128:131]
  s_waitcnt lgkmcnt(1)
  v_mfma_f32_16x16x32_bf16 v[128:131], v[28:31], v[124:127], v[128:131]
  v_mfma_f32_16x16x32_bf16 v[132:135], v[32:35], v[112:115], 0
  v_mfma_f32_16x16x32_bf16 v[132:135], v[36:39], v[116:119], v[132:135]
  v_mfma_f32_16x16x32_bf16 v[132:135], v[40:43], v[120:123], v[132:135]
  v_mfma_f32_16x16x32_bf16 v[132:135], v[44:47], v[124:127], v[132:135]
  ds_read_b32 v194, v204 offset:41088
  s_nop 2
  v_pk_mul_f32 v[184:185], v[128:129], v[198:199]
  v_pk_mul_f32 v[186:187], v[130:131], v[198:199]
  v_exp_f32 v128, v184
  v_exp_f32 v129, v185
  v_exp_f32 v130, v186
  v_exp_f32 v131, v187
  s_waitcnt lgkmcnt(0)
  v_readfirstlane_b32 s44, v194
  v_pk_mul_f32 v[188:189], v[132:133], v[198:199]
  v_pk_mul_f32 v[190:191], v[134:135], v[198:199]
  v_exp_f32 v132, v188
  v_exp_f32 v133, v189
  v_exp_f32 v134, v190
  v_exp_f32 v135, v191
  v_cvt_pk_bf16_f32 v136, v128, v129
  v_cvt_pk_bf16_f32 v137, v130, v131
  v_cvt_pk_bf16_f32 v138, v132, v133
  v_cvt_pk_bf16_f32 v139, v134, v135
  ds_write_b128 v4, v[136:139]
  v_max3_f32 v192, v184, v185, v186
  v_max3_f32 v193, v187, v188, v189
  v_max3_f32 v192, v192, v190, v191
  v_max_f32 v192, v192, v193
  v_cmp_gt_f32 vcc, |v192|, v197
  s_cbranch_vccnz L_fallback_75
L_pout_76:
  s_waitcnt lgkmcnt(0)
  s_barrier
  ds_read_b128 v[144:147], v15 offset:32768
  ds_read_b128 v[148:151], v15 offset:33792
  ds_read_b128 v[152:155], v15 offset:34816
  ds_read_b128 v[156:159], v15 offset:35840
  ds_read_b128 v[184:187], v3
  s_cmp_lg_u32 s44, 0
  s_waitcnt lgkmcnt(4)
  v_mfma_f32_16x16x32_bf16 v[128:131], v[144:147], v[80:83], 0
  v_mfma_f32_16x16x32_bf16 v[132:135], v[144:147], v[84:87], 0
  s_waitcnt lgkmcnt(3)
  v_mfma_f32_16x16x32_bf16 v[128:131], v[148:151], v[88:91], v[128:131]
  v_mfma_f32_16x16x32_bf16 v[132:135], v[148:151], v[92:95], v[132:135]
  s_waitcnt lgkmcnt(2)
  v_mfma_f32_16x16x32_bf16 v[128:131], v[152:155], v[96:99], v[128:131]
  v_mfma_f32_16x16x32_bf16 v[132:135], v[152:155], v[100:103], v[132:135]
  s_waitcnt lgkmcnt(1)
  v_mfma_f32_16x16x32_bf16 v[128:131], v[156:159], v[104:107], v[128:131]
  v_mfma_f32_16x16x32_bf16 v[132:135], v[156:159], v[108:111], v[132:135]
  s_waitcnt lgkmcnt(0)
  v_or3_b32 v192, v184, v185, v186
  v_or_b32 v192, v192, v187
  v_cmp_ne_u32 vcc, 0, v192
  s_cbranch_vccnz L_sgen_77
  s_nop 2
  v_cvt_pk_bf16_f32 v192, v128, v132
L_sst_78:
  s_cbranch_scc1 L_sslow_79
  global_store_dword v208, v192, s[42:43] offset:-2048
L_sdone_80:
  s_barrier
  s_waitcnt vmcnt(1)
  v_mov_b32 v192, 1
  s_mov_b64 s[38:39], exec
  s_mov_b64 exec, 1
  ds_add_u32 v204, v192 offset:41100
  s_mov_b64 exec, s[38:39]
  s_waitcnt lgkmcnt(0)
  s_barrier
  s_barrier
  s_barrier
  v_mov_b32 v196, 0
  s_waitcnt lgkmcnt(0)
  s_barrier
  ds_read_b128 v[112:115], v200
  ds_read_b128 v[116:119], v201
  ds_read_b128 v[120:123], v202
  ds_read_b128 v[124:127], v203
  ds_write_b32 v5, v196
  s_waitcnt lgkmcnt(4)
  v_mfma_f32_16x16x32_bf16 v[128:131], v[16:19], v[112:115], 0
  s_waitcnt lgkmcnt(3)
  v_mfma_f32_16x16x32_bf16 v[128:131], v[20:23], v[116:119], v[128:131]
  s_waitcnt lgkmcnt(2)
  v_mfma_f32_16x16x32_bf16 v[128:131], v[24:27], v[120:123], v[128:131]
  s_waitcnt lgkmcnt(1)
  v_mfma_f32_16x16x32_bf16 v[128:131], v[28:31], v[124:127], v[128:131]
  v_mfma_f32_16x16x32_bf16 v[132:135], v[32:35], v[112:115], 0
  v_mfma_f32_16x16x32_bf16 v[132:135], v[36:39], v[116:119], v[132:135]
  v_mfma_f32_16x16x32_bf16 v[132:135], v[40:43], v[120:123], v[132:135]
  v_mfma_f32_16x16x32_bf16 v[132:135], v[44:47], v[124:127], v[132:135]
  s_nop 3
  v_pk_mul_f32 v[184:185], v[128:129], v[198:199]
  v_pk_mul_f32 v[186:187], v[130:131], v[198:199]
  v_exp_f32 v128, v184
  v_exp_f32 v129, v185
  v_exp_f32 v130, v186
  v_exp_f32 v131, v187
  v_pk_mul_f32 v[188:189], v[132:133], v[198:199]
  v_pk_mul_f32 v[190:191], v[134:135], v[198:199]
  v_exp_f32 v132, v188
  v_exp_f32 v133, v189
  v_exp_f32 v134, v190
  v_exp_f32 v135, v191
  v_cvt_pk_bf16_f32 v136, v128, v129
  v_cvt_pk_bf16_f32 v137, v130, v131
  v_cvt_pk_bf16_f32 v138, v132, v133
  v_cvt_pk_bf16_f32 v139, v134, v135
  ds_write_b128 v4, v[136:139]
  v_max3_f32 v192, v184, v185, v186
  v_max3_f32 v193, v187, v188, v189
  v_max3_f32 v192, v192, v190, v191
  v_max_f32 v192, v192, v193
  v_cmp_gt_f32 vcc, |v192|, v197
  s_cbranch_vccnz L_fallback_81
L_pout_82:
  s_waitcnt lgkmcnt(0)
  s_barrier
  ds_read_b128 v[144:147], v15 offset:32768
  ds_read_b128 v[148:151], v15 offset:33792
  ds_read_b128 v[152:155], v15 offset:34816
  ds_read_b128 v[156:159], v15 offset:35840
  ds_read_b128 v[184:187], v3
  s_cmp_lg_u32 s44, 0
  s_waitcnt lgkmcnt(4)
  v_mfma_f32_16x16x32_bf16 v[128:131], v[144:147], v[80:83], 0
  v_mfma_f32_16x16x32_bf16 v[132:135], v[144:147], v[84:87], 0
  s_waitcnt lgkmcnt(3)
  v_mfma_f32_16x16x32_bf16 v[128:131], v[148:151], v[88:91], v[128:131]
  v_mfma_f32_16x16x32_bf16 v[132:135], v[148:151], v[92:95], v[132:135]
  s_waitcnt lgkmcnt(2)
  v_mfma_f32_16x16x32_bf16 v[128:131], v[152:155], v[96:99], v[128:131]
  v_mfma_f32_16x16x32_bf16 v[132:135], v[152:155], v[100:103], v[132:135]
  s_waitcnt lgkmcnt(1)
  v_mfma_f32_16x16x32_bf16 v[128:131], v[156:159], v[104:107], v[128:131]
  v_mfma_f32_16x16x32_bf16 v[132:135], v[156:159], v[108:111], v[132:135]
  s_waitcnt lgkmcnt(0)
  v_or3_b32 v192, v184, v185, v186
  v_or_b32 v192, v192, v187
  v_cmp_ne_u32 vcc, 0, v192
  s_cbranch_vccnz L_sgen_83
  s_nop 2
  v_cvt_pk_bf16_f32 v192, v128, v132
L_sst_84:
  s_cbranch_scc1 L_sslow_85
  global_store_dword v208, v192, s[42:43] offset:0
L_sdone_86:
  s_barrier
  s_endpgm
L_sslow_79:
  global_store_dword v208, v192, s[42:43] offset:-2048 sc1
  s_branch L_sdone_80
L_sgen_77:
  s_nop 7
  v_mfma_f32_16x16x32_bf16 v[48:51], v[144:147], v[80:83], 0
  v_mfma_f32_16x16x32_bf16 v[52:55], v[144:147], v[84:87], 0
  v_mfma_f32_16x16x32_bf16 v[56:59], v[148:151], v[88:91], 0
  v_mfma_f32_16x16x32_bf16 v[60:63], v[148:151], v[92:95], 0
  v_mfma_f32_16x16x32_bf16 v[64:67], v[152:155], v[96:99], 0
  v_mfma_f32_16x16x32_bf16 v[68:71], v[152:155], v[100:103], 0
  v_mfma_f32_16x16x32_bf16 v[72:75], v[156:159], v[104:107], 0
  v_mfma_f32_16x16x32_bf16 v[76:79], v[156:159], v[108:111], 0
  v_max3_f32 v192, v184, v185, v186
  v_max_f32 v192, v192, v187
  v_sub_f32 v184, v184, v192
  v_sub_f32 v185, v185, v192
  v_sub_f32 v186, v186, v192
  v_sub_f32 v187, v187, v192
  v_exp_f32 v184, v184
  v_exp_f32 v185, v185
  v_exp_f32 v186, v186
  v_exp_f32 v187, v187
  v_mul_f32 v192, v184, v48
  v_fmac_f32 v192, v185, v56
  v_fmac_f32 v192, v186, v64
  v_fmac_f32 v192, v187, v72
  v_mul_f32 v193, v184, v52
  v_fmac_f32 v193, v185, v60
  v_fmac_f32 v193, v186, v68
  v_fmac_f32 v193, v187, v76
  v_cvt_pk_bf16_f32 v192, v192, v193
  s_branch L_sst_78
L_fallback_75:
  s_nop 7
  v_mov_b32 v193, v192
  s_nop 1
  v_permlane32_swap_b32 v192, v193
  v_max_f32 v192, v192, v193
  v_mov_b32 v193, v192
  s_nop 1
  v_permlane16_swap_b32 v192, v193
  v_max_f32 v192, v192, v193
  v_sub_f32 v184, v184, v192
  v_sub_f32 v185, v185, v192
  v_sub_f32 v186, v186, v192
  v_sub_f32 v187, v187, v192
  v_sub_f32 v188, v188, v192
  v_sub_f32 v189, v189, v192
  v_sub_f32 v190, v190, v192
  v_sub_f32 v191, v191, v192
  v_exp_f32 v128, v184
  v_exp_f32 v129, v185
  v_exp_f32 v130, v186
  v_exp_f32 v131, v187
  v_exp_f32 v132, v188
  v_exp_f32 v133, v189
  v_exp_f32 v134, v190
  v_exp_f32 v135, v191
  v_cvt_pk_bf16_f32 v136, v128, v129
  v_cvt_pk_bf16_f32 v137, v130, v131
  v_cvt_pk_bf16_f32 v138, v132, v133
  v_cvt_pk_bf16_f32 v139, v134, v135
  ds_write_b32 v5, v192
  ds_write_b128 v4, v[136:139]
  s_branch L_pout_76
L_sslow_85:
  global_store_dword v208, v192, s[42:43] offset:0 sc1
  s_branch L_sdone_86
L_sgen_83:
  s_nop 7
  v_mfma_f32_16x16x32_bf16 v[48:51], v[144:147], v[80:83], 0
  v_mfma_f32_16x16x32_bf16 v[52:55], v[144:147], v[84:87], 0
  v_mfma_f32_16x16x32_bf16 v[56:59], v[148:151], v[88:91], 0
  v_mfma_f32_16x16x32_bf16 v[60:63], v[148:151], v[92:95], 0
  v_mfma_f32_16x16x32_bf16 v[64:67], v[152:155], v[96:99], 0
  v_mfma_f32_16x16x32_bf16 v[68:71], v[152:155], v[100:103], 0
  v_mfma_f32_16x16x32_bf16 v[72:75], v[156:159], v[104:107], 0
  v_mfma_f32_16x16x32_bf16 v[76:79], v[156:159], v[108:111], 0
  v_max3_f32 v192, v184, v185, v186
  v_max_f32 v192, v192, v187
  v_sub_f32 v184, v184, v192
  v_sub_f32 v185, v185, v192
  v_sub_f32 v186, v186, v192
  v_sub_f32 v187, v187, v192
  v_exp_f32 v184, v184
  v_exp_f32 v185, v185
  v_exp_f32 v186, v186
  v_exp_f32 v187, v187
  v_mul_f32 v192, v184, v48
  v_fmac_f32 v192, v185, v56
  v_fmac_f32 v192, v186, v64
  v_fmac_f32 v192, v187, v72
  v_mul_f32 v193, v184, v52
  v_fmac_f32 v193, v185, v60
  v_fmac_f32 v193, v186, v68
  v_fmac_f32 v193, v187, v76
  v_cvt_pk_bf16_f32 v192, v192, v193
  s_branch L_sst_84
L_fallback_81:
  s_nop 7
  v_mov_b32 v193, v192
  s_nop 1
  v_permlane32_swap_b32 v192, v193
  v_max_f32 v192, v192, v193
  v_mov_b32 v193, v192
  s_nop 1
  v_permlane16_swap_b32 v192, v193
  v_max_f32 v192, v192, v193
  v_sub_f32 v184, v184, v192
  v_sub_f32 v185, v185, v192
  v_sub_f32 v186, v186, v192
  v_sub_f32 v187, v187, v192
  v_sub_f32 v188, v188, v192
  v_sub_f32 v189, v189, v192
  v_sub_f32 v190, v190, v192
  v_sub_f32 v191, v191, v192
  v_exp_f32 v128, v184
  v_exp_f32 v129, v185
  v_exp_f32 v130, v186
  v_exp_f32 v131, v187
  v_exp_f32 v132, v188
  v_exp_f32 v133, v189
  v_exp_f32 v134, v190
  v_exp_f32 v135, v191
  v_cvt_pk_bf16_f32 v136, v128, v129
  v_cvt_pk_bf16_f32 v137, v130, v131
  v_cvt_pk_bf16_f32 v138, v132, v133
  v_cvt_pk_bf16_f32 v139, v134, v135
  ds_write_b32 v5, v192
  ds_write_b128 v4, v[136:139]
  s_branch L_pout_82
L_fast_end:
L_Yslow:
  s_barrier
  s_barrier
  global_load_dword v250, v253, s[46:47] offset:3328 sc1
  v_mov_b64 v[40:41], 0
  v_mov_b64 v[42:43], 0
  v_mov_b64 v[44:45], 0
  v_mov_b64 v[46:47], 0
  s_mov_b32 s65, 2000
  s_mov_b32 s58, 64
  global_load_dwordx4 v[230:233], v9, s[46:47] offset:1152 sc1
  global_load_dwordx4 v[234:237], v9, s[46:47] offset:1168 sc1
  global_load_short_d16_hi v214, v2, s[36:37] offset:-2048 sc1
  global_load_short_d16_hi v215, v2, s[36:37] offset:-1792 sc1
  global_load_short_d16_hi v216, v2, s[36:37] offset:-1536 sc1
  global_load_short_d16_hi v217, v2, s[36:37] offset:-1280 sc1
  global_load_short_d16_hi v218, v2, s[36:37] offset:-1024 sc1
  global_load_short_d16_hi v219, v2, s[36:37] offset:-768 sc1
  global_load_short_d16_hi v220, v2, s[36:37] offset:-512 sc1
  global_load_short_d16_hi v221, v2, s[36:37] offset:-256 sc1
  v_add_u32 v64, 75776, v8
  s_mov_b32 s65, 512000
L_cnt_92:
  ds_read_b32 v49, v76 offset:41100
  s_sub_u32 s65, s65, 1
  s_cbranch_scc1 L_exit
  s_waitcnt lgkmcnt(0)
  v_cmp_gt_u32 vcc, 4, v49
  s_cbranch_vccnz L_cnt_92
  ds_read_b128 v[144:147], v64 offset:0
  ds_read_b128 v[148:151], v64 offset:1024
  ds_read_b128 v[152:155], v64 offset:2048
  ds_read_b128 v[156:159], v64 offset:3072
  ds_read_b128 v[160:163], v64 offset:4096
  ds_read_b128 v[164:167], v64 offset:5120
  ds_read_b128 v[168:171], v64 offset:6144
  ds_read_b128 v[172:175], v64 offset:7168
  s_waitcnt lgkmcnt(6)
  v_perm_b32 v212, v148, v144, s62
  v_perm_b32 v148, v148, v144, s63
  v_perm_b32 v144, v149, v145, s62
  v_perm_b32 v149, v149, v145, s63
  v_perm_b32 v145, v150, v146, s62
  v_perm_b32 v150, v150, v146, s63
  v_perm_b32 v146, v151, v147, s62
  v_perm_b32 v151, v151, v147, s63
  s_waitcnt lgkmcnt(4)
  v_perm_b32 v147, v156, v152, s62
  v_perm_b32 v156, v156, v152, s63
  v_perm_b32 v152, v157, v153, s62
  v_perm_b32 v157, v157, v153, s63
  v_perm_b32 v153, v158, v154, s62
  v_perm_b32 v158, v158, v154, s63
  v_perm_b32 v154, v159, v155, s62
  v_perm_b32 v159, v159, v155, s63
  s_waitcnt lgkmcnt(2)
  v_perm_b32 v155, v164, v160, s62
  v_perm_b32 v164, v164, v160, s63
  v_perm_b32 v160, v165, v161, s62
  v_perm_b32 v165, v165, v161, s63
  v_perm_b32 v161, v166, v162, s62
  v_perm_b32 v166, v166, v162, s63
  v_perm_b32 v162, v167, v163, s62
  v_perm_b32 v167, v167, v163, s63
  s_waitcnt lgkmcnt(0)
  v_perm_b32 v163, v172, v168, s62
  v_perm_b32 v172, v172, v168, s63
  v_perm_b32 v168, v173, v169, s62
  v_perm_b32 v173, v173, v169, s63
  v_perm_b32 v169, v174, v170, s62
  v_perm_b32 v174, v174, v170, s63
  v_perm_b32 v170, v175, v171, s62
  v_perm_b32 v175, v175, v171, s63
  s_mov_b32 s65, 2000
  s_waitcnt vmcnt(25)
  v_perm_b32 v171, v84, v80, s62
  v_perm_b32 v84, v84, v80, s63
  v_perm_b32 v80, v85, v81, s62
  v_perm_b32 v85, v85, v81, s63
  v_perm_b32 v81, v86, v82, s62
  v_perm_b32 v86, v86, v82, s63
  v_perm_b32 v82, v87, v83, s62
  v_perm_b32 v87, v87, v83, s63
  s_waitcnt vmcnt(23)
  v_perm_b32 v83, v92, v88, s62
  v_perm_b32 v92, v92, v88, s63
  v_perm_b32 v88, v93, v89, s62
  v_perm_b32 v93, v93, v89, s63
  v_perm_b32 v89, v94, v90, s62
  v_perm_b32 v94, v94, v90, s63
  v_perm_b32 v90, v95, v91, s62
  v_perm_b32 v95, v95, v91, s63
  s_waitcnt vmcnt(21)
  v_perm_b32 v91, v100, v96, s62
  v_perm_b32 v100, v100, v96, s63
  v_perm_b32 v96, v101, v97, s62
  v_perm_b32 v101, v101, v97, s63
  v_perm_b32 v97, v102, v98, s62
  v_perm_b32 v102, v102, v98, s63
  v_perm_b32 v98, v103, v99, s62
  v_perm_b32 v103, v103, v99, s63
  s_waitcnt vmcnt(19)
  v_perm_b32 v99, v108, v104, s62
  v_perm_b32 v108, v108, v104, s63
  v_perm_b32 v104, v109, v105, s62
  v_perm_b32 v109, v109, v105, s63
  v_perm_b32 v105, v110, v106, s62
  v_perm_b32 v110, v110, v106, s63
  v_perm_b32 v106, v111, v107, s62
  v_perm_b32 v111, v111, v107, s63
  s_waitcnt vmcnt(17)
  v_perm_b32 v107, v116, v112, s62
  v_perm_b32 v116, v116, v112, s63
  v_perm_b32 v112, v117, v113, s62
  v_perm_b32 v117, v117, v113, s63
  v_perm_b32 v113, v118, v114, s62
  v_perm_b32 v118, v118, v114, s63
  v_perm_b32 v114, v119, v115, s62
  v_perm_b32 v119, v119, v115, s63
  s_waitcnt vmcnt(15)
  v_perm_b32 v115, v124, v120, s62
  v_perm_b32 v124, v124, v120, s63
  v_perm_b32 v120, v125, v121, s62
  v_perm_b32 v125, v125, v121, s63
  v_perm_b32 v121, v126, v122, s62
  v_perm_b32 v126, v126, v122, s63
  v_perm_b32 v122, v127, v123, s62
  v_perm_b32 v127, v127, v123, s63
  s_waitcnt vmcnt(13)
  v_perm_b32 v123, v132, v128, s62
  v_perm_b32 v132, v132, v128, s63
  v_perm_b32 v128, v133, v129, s62
  v_perm_b32 v133, v133, v129, s63
  v_perm_b32 v129, v134, v130, s62
  v_perm_b32 v134, v134, v130, s63
  v_perm_b32 v130, v135, v131, s62
  v_perm_b32 v135, v135, v131, s63
  s_waitcnt vmcnt(11)
  v_perm_b32 v131, v140, v136, s62
  v_perm_b32 v140, v140, v136, s63
  v_perm_b32 v136, v141, v137, s62
  v_perm_b32 v141, v141, v137, s63
  v_perm_b32 v137, v142, v138, s62
  v_perm_b32 v142, v142, v138, s63
  v_perm_b32 v138, v143, v139, s62
  v_perm_b32 v143, v143, v139, s63
  s_branch L_o_in_91
L_o_89:
  global_load_dwordx4 v[230:233], v9, s[46:47] offset:1152 sc1
  global_load_dwordx4 v[234:237], v9, s[46:47] offset:1168 sc1
  global_load_short_d16_hi v214, v2, s[36:37] offset:-2048 sc1
  global_load_short_d16_hi v215, v2, s[36:37] offset:-1792 sc1
  global_load_short_d16_hi v216, v2, s[36:37] offset:-1536 sc1
  global_load_short_d16_hi v217, v2, s[36:37] offset:-1280 sc1
  global_load_short_d16_hi v218, v2, s[36:37] offset:-1024 sc1
  global_load_short_d16_hi v219, v2, s[36:37] offset:-768 sc1
  global_load_short_d16_hi v220, v2, s[36:37] offset:-512 sc1
  global_load_short_d16_hi v221, v2, s[36:37] offset:-256 sc1
L_o_in_91:
  s_sub_u32 s58, s58, 1
  s_cbranch_scc1 L_o_over_90
  s_waitcnt vmcnt(4)
  v_pk_add_f32 v[20:21], v[214:215], v[216:217]
  v_pk_add_f32 v[36:37], v[230:231], v[232:233]
  v_pk_add_f32 v[38:39], v[234:235], v[236:237]
  v_pk_add_f32 v[36:37], v[36:37], v[38:39]
  v_add_f32 v36, v36, v37
  s_waitcnt vmcnt(0)
  v_pk_add_f32 v[22:23], v[218:219], v[220:221]
  v_pk_add_f32 v[20:21], v[20:21], v[22:23]
  v_add_f32 v20, v20, v21
  v_cmp_u_f32 vcc, v20, v36
  v_or3_b32 v50, v230, v231, v232
  v_permlane32_swap_b32 v20, v36
  v_add_f32 v20, v20, v36
  v_mov_b32 v48, v20
  s_cbranch_vccnz L_o_89
  v_or3_b32 v50, v50, v233, v234
  v_permlane16_swap_b32 v20, v48
  v_add_f32 v20, v20, v48
  v_mov_b32 v36, v20
  v_or3_b32 v50, v50, v235, v236
  v_or_b32 v50, v50, v237
  v_permlane32_swap_b32 v20, v36
  v_rcp_f32 v36, v36
  v_cmp_gt_i32 vcc, 0, v50
  v_mul_f32 v20, v20, v36
  s_nop 1
  v_mov_b32_dpp v48, v20 quad_perm:[1,0,3,2] row_mask:0xf bank_mask:0xf
  v_cvt_pk_bf16_f32 v16, v20, v48
  s_cbranch_vccnz L_ogen_88
L_onorm_87:
  global_store_dwordx4 v15, v[72:75], s[36:37] offset:-2048 sc1
  v_readlane_b32 s4, v16, 0
  v_readlane_b32 s5, v16, 2
  v_readlane_b32 s6, v16, 4
  v_dot2c_f32_bf16 v40, s4, v171
  v_dot2c_f32_bf16 v41, s4, v84
  v_readlane_b32 s7, v16, 6
  v_dot2c_f32_bf16 v42, s4, v80
  v_dot2c_f32_bf16 v43, s4, v85
  v_dot2c_f32_bf16 v44, s4, v81
  v_dot2c_f32_bf16 v45, s4, v86
  v_dot2c_f32_bf16 v46, s4, v82
  v_dot2c_f32_bf16 v47, s4, v87
  v_dot2c_f32_bf16 v40, s5, v83
  v_dot2c_f32_bf16 v41, s5, v92
  v_readlane_b32 s8, v16, 8
  v_dot2c_f32_bf16 v42, s5, v88
  v_dot2c_f32_bf16 v43, s5, v93
  v_dot2c_f32_bf16 v44, s5, v89
  v_dot2c_f32_bf16 v45, s5, v94
  v_dot2c_f32_bf16 v46, s5, v90
  v_dot2c_f32_bf16 v47, s5, v95
  v_dot2c_f32_bf16 v40, s6, v91
  v_dot2c_f32_bf16 v41, s6, v100
  v_readlane_b32 s9, v16, 10
  v_dot2c_f32_bf16 v42, s6, v96
  v_dot2c_f32_bf16 v43, s6, v101
  v_dot2c_f32_bf16 v44, s6, v97
  v_dot2c_f32_bf16 v45, s6, v102
  v_dot2c_f32_bf16 v46, s6, v98
  v_dot2c_f32_bf16 v47, s6, v103
  v_dot2c_f32_bf16 v40, s7, v99
  v_dot2c_f32_bf16 v41, s7, v108
  v_readlane_b32 s10, v16, 12
  v_dot2c_f32_bf16 v42, s7, v104
  v_dot2c_f32_bf16 v43, s7, v109
  v_dot2c_f32_bf16 v44, s7, v105
  v_dot2c_f32_bf16 v45, s7, v110
  v_dot2c_f32_bf16 v46, s7, v106
  v_dot2c_f32_bf16 v47, s7, v111
  v_dot2c_f32_bf16 v40, s8, v107
  v_dot2c_f32_bf16 v41, s8, v116
  v_readlane_b32 s11, v16, 14
  v_dot2c_f32_bf16 v42, s8, v112
  v_dot2c_f32_bf16 v43, s8, v117
  v_dot2c_f32_bf16 v44, s8, v113
  v_dot2c_f32_bf16 v45, s8, v118
  v_dot2c_f32_bf16 v46, s8, v114
  v_dot2c_f32_bf16 v47, s8, v119
  v_dot2c_f32_bf16 v40, s9, v115
  v_dot2c_f32_bf16 v41, s9, v124
  v_dot2c_f32_bf16 v42, s9, v120
  v_dot2c_f32_bf16 v43, s9, v125
  v_dot2c_f32_bf16 v44, s9, v121
  v_dot2c_f32_bf16 v45, s9, v126
  v_dot2c_f32_bf16 v46, s9, v122
  v_dot2c_f32_bf16 v47, s9, v127
  v_dot2c_f32_bf16 v40, s10, v123
  v_dot2c_f32_bf16 v41, s10, v132
  v_dot2c_f32_bf16 v42, s10, v128
  v_dot2c_f32_bf16 v43, s10, v133
  v_dot2c_f32_bf16 v44, s10, v129
  v_dot2c_f32_bf16 v45, s10, v134
  v_dot2c_f32_bf16 v46, s10, v130
  v_dot2c_f32_bf16 v47, s10, v135
  v_dot2c_f32_bf16 v40, s11, v131
  v_dot2c_f32_bf16 v41, s11, v140
  v_dot2c_f32_bf16 v42, s11, v136
  v_dot2c_f32_bf16 v43, s11, v141
  v_dot2c_f32_bf16 v44, s11, v137
  v_dot2c_f32_bf16 v45, s11, v142
  v_dot2c_f32_bf16 v46, s11, v138
  v_dot2c_f32_bf16 v47, s11, v143
  v_cvt_pk_bf16_f32 v48, v40, v41
  v_cvt_pk_bf16_f32 v49, v42, v43
  v_cvt_pk_bf16_f32 v50, v44, v45
  v_cvt_pk_bf16_f32 v51, v46, v47
  s_waitcnt vmcnt(0)
  global_store_dwordx4 v3, v[48:51], s[36:37] offset:0 sc1
  s_barrier
  s_nop 0
  v_and_b32 v49, 0xffff, v250
  v_cmp_eq_u32 vcc, s25, v49
  v_ashrrev_i32 v48, 16, v250
  s_nop 0
  v_cndmask_b32 v48, 0, v48, vcc
  s_nop 1
  v_add_u32_dpp v48, v48, v48 row_ror:8 row_mask:0xf bank_mask:0xf
  s_nop 1
  v_add_u32_dpp v48, v48, v48 row_ror:4 row_mask:0xf bank_mask:0xf
  s_nop 1
  v_add_u32_dpp v48, v48, v48 row_ror:2 row_mask:0xf bank_mask:0xf
  s_nop 1
  v_add_u32_dpp v48, v48, v48 row_ror:1 row_mask:0xf bank_mask:0xf
  v_mov_b32 v49, v48
  s_nop 1
  v_permlane16_swap_b32 v48, v49
  v_add_u32 v48, v48, v49
  s_ashr_i32 s30, s24, 16
  v_add_u32 v48, s30, v48
  ds_write_b32 v76, v48 offset:41104
  s_cmp_lt_u32 s29, 28
  s_cbranch_scc0 L_nocg_95
  s_sleep 7
  s_mov_b32 s65, 2000
  s_mov_b32 s58, 64
L_cs_97:
  global_load_short_d16_hi v214, v2, s[36:37] offset:2048 sc1
  global_load_short_d16_hi v215, v2, s[36:37] offset:2304 sc1
  global_load_short_d16_hi v216, v2, s[36:37] offset:2560 sc1
  global_load_short_d16_hi v217, v2, s[36:37] offset:2816 sc1
  global_load_short_d16_hi v218, v2, s[36:37] offset:3072 sc1
  global_load_short_d16_hi v219, v2, s[36:37] offset:3328 sc1
  global_load_short_d16_hi v220, v2, s[36:37] offset:3584 sc1
  global_load_short_d16_hi v221, v2, s[36:37] offset:3840 sc1
  s_sub_u32 s58, s58, 1
  s_cbranch_scc1 L_cs_over_98
  s_waitcnt vmcnt(4)
  v_pk_add_f32 v[20:21], v[214:215], v[216:217]
  s_waitcnt vmcnt(0)
  v_pk_add_f32 v[22:23], v[218:219], v[220:221]
  v_pk_add_f32 v[20:21], v[20:21], v[22:23]
  v_add_f32 v20, v20, v21
  v_mov_b32 v48, v20
  v_cmp_u_f32 vcc, v20, v20
  s_nop 0
  v_permlane32_swap_b32 v20, v48
  v_add_f32 v20, v20, v48
  v_mov_b32 v48, v20
  s_cbranch_vccnz L_cs_97
L_cs_done_96:
  s_nop 0
  v_permlane16_swap_b32 v20, v48
  v_add_f32 v20, v20, v48
  v_mov_b32 v14, v20
  global_store_dwordx4 v15, v[72:75], s[36:37] offset:2048 sc1
L_nocg_95:
  v_mov_b64 v[40:41], 0
  v_mov_b64 v[42:43], 0
  v_mov_b64 v[44:45], 0
  v_mov_b64 v[46:47], 0
  s_barrier
  s_cmp_lt_u32 s29, 28
  s_cbranch_scc0 L_noffn_94
  s_mov_b32 s65, 2000
  s_mov_b32 s58, 128000
  v_mov_b64 v[52:53], 0
  v_mov_b32 v54, 0x3b000000
  v_mov_b32 v55, 0x3727c5ac
  s_sleep 5
  global_load_dwordx4 v[238:241], v8, s[46:47] offset:-2048 sc1
  s_nop 15
  s_nop 0
  global_load_dwordx4 v[238:241], v8, s[46:47] offset:-2048 sc1
  s_nop 15
  s_nop 0
  global_load_dwordx4 v[238:241], v8, s[46:47] offset:-2048 sc1
  s_waitcnt vmcnt(2)
  v_max3_u32 v48, v238, v239, v240
  v_max_u32 v48, v48, v241
  v_cmp_eq_u32 vcc, -1, v48
  s_cbranch_vccz L_xok_101
  s_waitcnt vmcnt(1)
  v_max3_u32 v48, v238, v239, v240
  v_max_u32 v48, v48, v241
  v_cmp_eq_u32 vcc, -1, v48
  s_cbranch_vccz L_xok_101
  s_waitcnt vmcnt(0)
  v_max3_u32 v48, v238, v239, v240
  v_max_u32 v48, v48, v241
  v_cmp_eq_u32 vcc, -1, v48
  s_cbranch_vccnz L_xretry_100
L_xok_101:
  v_dot2c_f32_bf16 v52, s64, v238
  v_dot2c_f32_bf16 v53, v238, v238
  v_dot2c_f32_bf16 v52, s64, v239
  v_dot2c_f32_bf16 v53, v239, v239
  v_dot2c_f32_bf16 v52, s64, v240
  v_dot2c_f32_bf16 v53, v240, v240
  v_dot2c_f32_bf16 v52, s64, v241
  v_dot2c_f32_bf16 v53, v241, v241
  global_load_short_d16_hi v214, v2, s[36:37] offset:-2048 sc1
  global_load_short_d16_hi v215, v2, s[36:37] offset:-1792 sc1
  global_load_short_d16_hi v216, v2, s[36:37] offset:-1536 sc1
  v_permlane32_swap_b32 v52, v53
  v_add_f32 v52, v52, v53
  v_mov_b32 v53, v52
  global_load_short_d16_hi v217, v2, s[36:37] offset:-1280 sc1
  global_load_short_d16_hi v218, v2, s[36:37] offset:-1024 sc1
  v_permlane16_swap_b32 v52, v53
  v_add_f32 v52, v52, v53
  global_load_short_d16_hi v219, v2, s[36:37] offset:-768 sc1
  global_load_short_d16_hi v220, v2, s[36:37] offset:-512 sc1
  v_add_f32_dpp v52, v52, v52 row_ror:8 row_mask:0xf bank_mask:0xf
  global_load_short_d16_hi v221, v2, s[36:37] offset:-256 sc1
  global_load_short_d16_hi v214, v2, s[36:37] offset:-2048 sc1
  v_add_f32_dpp v52, v52, v52 row_ror:4 row_mask:0xf bank_mask:0xf
  global_load_short_d16_hi v215, v2, s[36:37] offset:-1792 sc1
  global_load_short_d16_hi v216, v2, s[36:37] offset:-1536 sc1
  v_add_f32_dpp v52, v52, v52 row_ror:2 row_mask:0xf bank_mask:0xf
  global_load_short_d16_hi v217, v2, s[36:37] offset:-1280 sc1
  global_load_short_d16_hi v218, v2, s[36:37] offset:-1024 sc1
  v_add_f32_dpp v52, v52, v52 row_ror:1 row_mask:0xf bank_mask:0xf
  global_load_short_d16_hi v219, v2, s[36:37] offset:-768 sc1
  v_readlane_b32 s30, v52, 0
  v_readlane_b32 s31, v52, 32
  global_load_short_d16_hi v220, v2, s[36:37] offset:-512 sc1
  v_mul_f32 v17, s30, v54
  v_fma_f32 v18, s31, v54, v55
  v_fma_f32 v18, -v17, v17, v18
  v_max_f32 v18, v18, v55
  v_rsq_f32 v18, v18
  global_load_short_d16_hi v221, v2, s[36:37] offset:-256 sc1
  s_mov_b32 s58, 64
  v_mul_f32 v19, v17, v18
  v_mul_f32_e64 v19, -v19, v14
L_gu_102_c:
  s_waitcnt vmcnt(12)
  v_pk_add_f32 v[20:21], v[214:215], v[216:217]
  s_waitcnt vmcnt(8)
  v_pk_add_f32 v[22:23], v[218:219], v[220:221]
  v_pk_add_f32 v[20:21], v[20:21], v[22:23]
  v_add_f32 v20, v20, v21
  v_mov_b32 v48, v20
  v_cmp_u_f32 vcc, v20, v20
  s_nop 0
  v_permlane32_swap_b32 v20, v48
  v_add_f32 v20, v20, v48
  v_mov_b32 v48, v20
  s_cbranch_vccnz L_gu_102
L_gu_done_99:
  s_nop 0
  v_permlane16_swap_b32 v20, v48
  v_add_f32 v20, v20, v48
  global_store_dwordx4 v15, v[72:75], s[36:37] offset:-2048 sc1
  v_fma_f32 v20, v20, v18, v19
  s_nop 1
  v_mul_f32_dpp v20, v20, v20 row_ror:8 row_mask:0xf bank_mask:0xf
  s_nop 1
  v_mov_b32_dpp v48, v20 quad_perm:[1,0,3,2] row_mask:0xf bank_mask:0xf
  v_cvt_pk_bf16_f32 v16, v20, v48
  s_nop 0
  v_readlane_b32 s4, v16, 0
  v_readlane_b32 s5, v16, 2
  v_readlane_b32 s6, v16, 4
  v_dot2c_f32_bf16 v40, s4, v212
  v_dot2c_f32_bf16 v41, s4, v148
  v_readlane_b32 s7, v16, 6
  v_dot2c_f32_bf16 v42, s4, v144
  v_dot2c_f32_bf16 v43, s4, v149
  v_dot2c_f32_bf16 v44, s4, v145
  v_dot2c_f32_bf16 v45, s4, v150
  v_dot2c_f32_bf16 v46, s4, v146
  v_dot2c_f32_bf16 v47, s4, v151
  v_dot2c_f32_bf16 v40, s5, v147
  v_dot2c_f32_bf16 v41, s5, v156
  v_dot2c_f32_bf16 v42, s5, v152
  v_dot2c_f32_bf16 v43, s5, v157
  v_dot2c_f32_bf16 v44, s5, v153
  v_dot2c_f32_bf16 v45, s5, v158
  v_dot2c_f32_bf16 v46, s5, v154
  v_dot2c_f32_bf16 v47, s5, v159
  v_dot2c_f32_bf16 v40, s6, v155
  v_dot2c_f32_bf16 v41, s6, v164
  v_dot2c_f32_bf16 v42, s6, v160
  v_dot2c_f32_bf16 v43, s6, v165
  v_dot2c_f32_bf16 v44, s6, v161
  v_dot2c_f32_bf16 v45, s6, v166
  v_dot2c_f32_bf16 v46, s6, v162
  v_dot2c_f32_bf16 v47, s6, v167
  v_dot2c_f32_bf16 v40, s7, v163
  v_dot2c_f32_bf16 v41, s7, v172
  v_dot2c_f32_bf16 v42, s7, v168
  v_dot2c_f32_bf16 v43, s7, v173
  v_dot2c_f32_bf16 v44, s7, v169
  v_dot2c_f32_bf16 v45, s7, v174
  v_dot2c_f32_bf16 v46, s7, v170
  v_dot2c_f32_bf16 v47, s7, v175
  v_cvt_pk_bf16_f32 v48, v40, v41
  v_cvt_pk_bf16_f32 v49, v42, v43
  v_cvt_pk_bf16_f32 v50, v44, v45
  v_cvt_pk_bf16_f32 v51, v46, v47
  s_waitcnt vmcnt(0)
  global_store_dwordx4 v3, v[48:51], s[36:37] offset:0 sc1
L_noffn_94:
  s_barrier
  s_barrier
  s_barrier
  s_barrier
  v_mov_b64 v[40:41], 0
  v_mov_b64 v[42:43], 0
  v_mov_b64 v[44:45], 0
  v_mov_b64 v[46:47], 0
  s_mov_b32 s65, 2000
  s_mov_b32 s58, 64
  s_nop 15
  s_nop 3
  global_load_dwordx4 v[230:233], v9, s[46:47] offset:2176 sc1
  global_load_dwordx4 v[234:237], v9, s[46:47] offset:2192 sc1
  global_load_short_d16_hi v214, v2, s[36:37] offset:0 sc1
  global_load_short_d16_hi v215, v2, s[36:37] offset:256 sc1
  global_load_short_d16_hi v216, v2, s[36:37] offset:512 sc1
  global_load_short_d16_hi v217, v2, s[36:37] offset:768 sc1
  global_load_short_d16_hi v218, v2, s[36:37] offset:1024 sc1
  global_load_short_d16_hi v219, v2, s[36:37] offset:1280 sc1
  global_load_short_d16_hi v220, v2, s[36:37] offset:1536 sc1
  global_load_short_d16_hi v221, v2, s[36:37] offset:1792 sc1
  s_nop 14
  global_load_dwordx4 v[230:233], v9, s[46:47] offset:2176 sc1
  global_load_dwordx4 v[234:237], v9, s[46:47] offset:2192 sc1
  global_load_short_d16_hi v214, v2, s[36:37] offset:0 sc1
  global_load_short_d16_hi v215, v2, s[36:37] offset:256 sc1
  global_load_short_d16_hi v216, v2, s[36:37] offset:512 sc1
  global_load_short_d16_hi v217, v2, s[36:37] offset:768 sc1
  global_load_short_d16_hi v218, v2, s[36:37] offset:1024 sc1
  global_load_short_d16_hi v219, v2, s[36:37] offset:1280 sc1
  global_load_short_d16_hi v220, v2, s[36:37] offset:1536 sc1
  global_load_short_d16_hi v221, v2, s[36:37] offset:1792 sc1
  s_nop 14
L_o_106:
  global_load_dwordx4 v[230:233], v9, s[46:47] offset:2176 sc1
  global_load_dwordx4 v[234:237], v9, s[46:47] offset:2192 sc1
  global_load_short_d16_hi v214, v2, s[36:37] offset:0 sc1
  global_load_short_d16_hi v215, v2, s[36:37] offset:256 sc1
  global_load_short_d16_hi v216, v2, s[36:37] offset:512 sc1
  global_load_short_d16_hi v217, v2, s[36:37] offset:768 sc1
  global_load_short_d16_hi v218, v2, s[36:37] offset:1024 sc1
  global_load_short_d16_hi v219, v2, s[36:37] offset:1280 sc1
  global_load_short_d16_hi v220, v2, s[36:37] offset:1536 sc1
  global_load_short_d16_hi v221, v2, s[36:37] offset:1792 sc1
  s_sub_u32 s58, s58, 1
  s_cbranch_scc1 L_o_over_107
  s_waitcnt vmcnt(24)
  v_pk_add_f32 v[20:21], v[214:215], v[216:217]
  v_pk_add_f32 v[36:37], v[230:231], v[232:233]
  v_pk_add_f32 v[38:39], v[234:235], v[236:237]
  v_pk_add_f32 v[36:37], v[36:37], v[38:39]
  v_add_f32 v36, v36, v37
  s_waitcnt vmcnt(20)
  v_pk_add_f32 v[22:23], v[218:219], v[220:221]
  v_pk_add_f32 v[20:21], v[20:21], v[22:23]
  v_add_f32 v20, v20, v21
  v_cmp_u_f32 vcc, v20, v36
  v_or3_b32 v50, v230, v231, v232
  v_permlane32_swap_b32 v20, v36
  v_add_f32 v20, v20, v36
  v_mov_b32 v48, v20
  s_cbranch_vccnz L_o_106
  v_or3_b32 v50, v50, v233, v234
  v_permlane16_swap_b32 v20, v48
  v_add_f32 v20, v20, v48
  v_mov_b32 v36, v20
  v_or3_b32 v50, v50, v235, v236
  v_or_b32 v50, v50, v237
  v_permlane32_swap_b32 v20, v36
  v_rcp_f32 v36, v36
  v_cmp_gt_i32 vcc, 0, v50
  v_mul_f32 v20, v20, v36
  s_nop 1
  v_mov_b32_dpp v48, v20 quad_perm:[1,0,3,2] row_mask:0xf bank_mask:0xf
  v_cvt_pk_bf16_f32 v16, v20, v48
  s_cbranch_vccnz L_ogen_105
L_onorm_104:
  global_store_dwordx4 v15, v[72:75], s[36:37] offset:0 sc1
  v_readlane_b32 s4, v16, 0
  v_readlane_b32 s5, v16, 2
  v_readlane_b32 s6, v16, 4
  v_dot2c_f32_bf16 v40, s4, v171
  v_dot2c_f32_bf16 v41, s4, v84
  v_readlane_b32 s7, v16, 6
  v_dot2c_f32_bf16 v42, s4, v80
  v_dot2c_f32_bf16 v43, s4, v85
  v_dot2c_f32_bf16 v44, s4, v81
  v_dot2c_f32_bf16 v45, s4, v86
  v_dot2c_f32_bf16 v46, s4, v82
  v_dot2c_f32_bf16 v47, s4, v87
  v_dot2c_f32_bf16 v40, s5, v83
  v_dot2c_f32_bf16 v41, s5, v92
  v_readlane_b32 s8, v16, 8
  v_dot2c_f32_bf16 v42, s5, v88
  v_dot2c_f32_bf16 v43, s5, v93
  v_dot2c_f32_bf16 v44, s5, v89
  v_dot2c_f32_bf16 v45, s5, v94
  v_dot2c_f32_bf16 v46, s5, v90
  v_dot2c_f32_bf16 v47, s5, v95
  v_dot2c_f32_bf16 v40, s6, v91
  v_dot2c_f32_bf16 v41, s6, v100
  v_readlane_b32 s9, v16, 10
  v_dot2c_f32_bf16 v42, s6, v96
  v_dot2c_f32_bf16 v43, s6, v101
  v_dot2c_f32_bf16 v44, s6, v97
  v_dot2c_f32_bf16 v45, s6, v102
  v_dot2c_f32_bf16 v46, s6, v98
  v_dot2c_f32_bf16 v47, s6, v103
  v_dot2c_f32_bf16 v40, s7, v99
  v_dot2c_f32_bf16 v41, s7, v108
  v_readlane_b32 s10, v16, 12
  v_dot2c_f32_bf16 v42, s7, v104
  v_dot2c_f32_bf16 v43, s7, v109
  v_dot2c_f32_bf16 v44, s7, v105
  v_dot2c_f32_bf16 v45, s7, v110
  v_dot2c_f32_bf16 v46, s7, v106
  v_dot2c_f32_bf16 v47, s7, v111
  v_dot2c_f32_bf16 v40, s8, v107
  v_dot2c_f32_bf16 v41, s8, v116
  v_readlane_b32 s11, v16, 14
  v_dot2c_f32_bf16 v42, s8, v112
  v_dot2c_f32_bf16 v43, s8, v117
  v_dot2c_f32_bf16 v44, s8, v113
  v_dot2c_f32_bf16 v45, s8, v118
  v_dot2c_f32_bf16 v46, s8, v114
  v_dot2c_f32_bf16 v47, s8, v119
  v_dot2c_f32_bf16 v40, s9, v115
  v_dot2c_f32_bf16 v41, s9, v124
  v_dot2c_f32_bf16 v42, s9, v120
  v_dot2c_f32_bf16 v43, s9, v125
  v_dot2c_f32_bf16 v44, s9, v121
  v_dot2c_f32_bf16 v45, s9, v126
  v_dot2c_f32_bf16 v46, s9, v122
  v_dot2c_f32_bf16 v47, s9, v127
  v_dot2c_f32_bf16 v40, s10, v123
  v_dot2c_f32_bf16 v41, s10, v132
  v_dot2c_f32_bf16 v42, s10, v128
  v_dot2c_f32_bf16 v43, s10, v133
  v_dot2c_f32_bf16 v44, s10, v129
  v_dot2c_f32_bf16 v45, s10, v134
  v_dot2c_f32_bf16 v46, s10, v130
  v_dot2c_f32_bf16 v47, s10, v135
  v_dot2c_f32_bf16 v40, s11, v131
  v_dot2c_f32_bf16 v41, s11, v140
  v_dot2c_f32_bf16 v42, s11, v136
  v_dot2c_f32_bf16 v43, s11, v141
  v_dot2c_f32_bf16 v44, s11, v137
  v_dot2c_f32_bf16 v45, s11, v142
  v_dot2c_f32_bf16 v46, s11, v138
  v_dot2c_f32_bf16 v47, s11, v143
  v_cvt_pk_bf16_f32 v48, v40, v41
  v_cvt_pk_bf16_f32 v49, v42, v43
  v_cvt_pk_bf16_f32 v50, v44, v45
  v_cvt_pk_bf16_f32 v51, v46, v47
  s_waitcnt vmcnt(0)
  global_store_dwordx4 v3, v[48:51], s[36:37] offset:-2048 sc1
  s_barrier
  v_mov_b64 v[40:41], 0
  v_mov_b64 v[42:43], 0
  v_mov_b64 v[44:45], 0
  v_mov_b64 v[46:47], 0
  s_barrier
  s_cmp_lt_u32 s29, 28
  s_cbranch_scc0 L_noffn_109
  s_mov_b32 s65, 2000
  s_mov_b32 s58, 128000
  v_mov_b64 v[52:53], 0
  v_mov_b32 v54, 0x3b000000
  v_mov_b32 v55, 0x3727c5ac
  s_sleep 5
  global_load_dwordx4 v[238:241], v8, s[46:47] offset:0 sc1
  s_nop 15
  s_nop 0
  global_load_dwordx4 v[238:241], v8, s[46:47] offset:0 sc1
  s_nop 15
  s_nop 0
  global_load_dwordx4 v[238:241], v8, s[46:47] offset:0 sc1
  s_waitcnt vmcnt(2)
  v_max3_u32 v48, v238, v239, v240
  v_max_u32 v48, v48, v241
  v_cmp_eq_u32 vcc, -1, v48
  s_cbranch_vccz L_xok_112
  s_waitcnt vmcnt(1)
  v_max3_u32 v48, v238, v239, v240
  v_max_u32 v48, v48, v241
  v_cmp_eq_u32 vcc, -1, v48
  s_cbranch_vccz L_xok_112
  s_waitcnt vmcnt(0)
  v_max3_u32 v48, v238, v239, v240
  v_max_u32 v48, v48, v241
  v_cmp_eq_u32 vcc, -1, v48
  s_cbranch_vccnz L_xretry_111
L_xok_112:
  v_dot2c_f32_bf16 v52, s64, v238
  v_dot2c_f32_bf16 v53, v238, v238
  v_dot2c_f32_bf16 v52, s64, v239
  v_dot2c_f32_bf16 v53, v239, v239
  v_dot2c_f32_bf16 v52, s64, v240
  v_dot2c_f32_bf16 v53, v240, v240
  v_dot2c_f32_bf16 v52, s64, v241
  v_dot2c_f32_bf16 v53, v241, v241
  global_load_short_d16_hi v214, v2, s[36:37] offset:0 sc1
  global_load_short_d16_hi v215, v2, s[36:37] offset:256 sc1
  global_load_short_d16_hi v216, v2, s[36:37] offset:512 sc1
  v_permlane32_swap_b32 v52, v53
  v_add_f32 v52, v52, v53
  v_mov_b32 v53, v52
  global_load_short_d16_hi v217, v2, s[36:37] offset:768 sc1
  global_load_short_d16_hi v218, v2, s[36:37] offset:1024 sc1
  v_permlane16_swap_b32 v52, v53
  v_add_f32 v52, v52, v53
  global_load_short_d16_hi v219, v2, s[36:37] offset:1280 sc1
  global_load_short_d16_hi v220, v2, s[36:37] offset:1536 sc1
  v_add_f32_dpp v52, v52, v52 row_ror:8 row_mask:0xf bank_mask:0xf
  global_load_short_d16_hi v221, v2, s[36:37] offset:1792 sc1
  global_load_short_d16_hi v214, v2, s[36:37] offset:0 sc1
  v_add_f32_dpp v52, v52, v52 row_ror:4 row_mask:0xf bank_mask:0xf
  global_load_short_d16_hi v215, v2, s[36:37] offset:256 sc1
  global_load_short_d16_hi v216, v2, s[36:37] offset:512 sc1
  v_add_f32_dpp v52, v52, v52 row_ror:2 row_mask:0xf bank_mask:0xf
  global_load_short_d16_hi v217, v2, s[36:37] offset:768 sc1
  global_load_short_d16_hi v218, v2, s[36:37] offset:1024 sc1
  v_add_f32_dpp v52, v52, v52 row_ror:1 row_mask:0xf bank_mask:0xf
  global_load_short_d16_hi v219, v2, s[36:37] offset:1280 sc1
  v_readlane_b32 s30, v52, 0
  v_readlane_b32 s31, v52, 32
  global_load_short_d16_hi v220, v2, s[36:37] offset:1536 sc1
  v_mul_f32 v17, s30, v54
  v_fma_f32 v18, s31, v54, v55
  v_fma_f32 v18, -v17, v17, v18
  v_max_f32 v18, v18, v55
  v_rsq_f32 v18, v18
  global_load_short_d16_hi v221, v2, s[36:37] offset:1792 sc1
  s_mov_b32 s58, 64
  v_mul_f32 v19, v17, v18
  v_mul_f32_e64 v19, -v19, v14
L_gu_113_c:
  s_waitcnt vmcnt(12)
  v_pk_add_f32 v[20:21], v[214:215], v[216:217]
  s_waitcnt vmcnt(8)
  v_pk_add_f32 v[22:23], v[218:219], v[220:221]
  v_pk_add_f32 v[20:21], v[20:21], v[22:23]
  v_add_f32 v20, v20, v21
  v_mov_b32 v48, v20
  v_cmp_u_f32 vcc, v20, v20
  s_nop 0
  v_permlane32_swap_b32 v20, v48
  v_add_f32 v20, v20, v48
  v_mov_b32 v48, v20
  s_cbranch_vccnz L_gu_113
L_gu_done_110:
  s_nop 0
  v_permlane16_swap_b32 v20, v48
  v_add_f32 v20, v20, v48
  v_fma_f32 v20, v20, v18, v19
  s_nop 1
  v_mul_f32_dpp v20, v20, v20 row_ror:8 row_mask:0xf bank_mask:0xf
  s_nop 1
  v_mov_b32_dpp v48, v20 quad_perm:[1,0,3,2] row_mask:0xf bank_mask:0xf
  v_cvt_pk_bf16_f32 v16, v20, v48
  s_nop 0
  v_readlane_b32 s4, v16, 0
  v_readlane_b32 s5, v16, 2
  v_readlane_b32 s6, v16, 4
  v_dot2c_f32_bf16 v40, s4, v212
  v_dot2c_f32_bf16 v41, s4, v148
  v_readlane_b32 s7, v16, 6
  v_dot2c_f32_bf16 v42, s4, v144
  v_dot2c_f32_bf16 v43, s4, v149
  v_dot2c_f32_bf16 v44, s4, v145
  v_dot2c_f32_bf16 v45, s4, v150
  v_dot2c_f32_bf16 v46, s4, v146
  v_dot2c_f32_bf16 v47, s4, v151
  v_dot2c_f32_bf16 v40, s5, v147
  v_dot2c_f32_bf16 v41, s5, v156
  v_dot2c_f32_bf16 v42, s5, v152
  v_dot2c_f32_bf16 v43, s5, v157
  v_dot2c_f32_bf16 v44, s5, v153
  v_dot2c_f32_bf16 v45, s5, v158
  v_dot2c_f32_bf16 v46, s5, v154
  v_dot2c_f32_bf16 v47, s5, v159
  v_dot2c_f32_bf16 v40, s6, v155
  v_dot2c_f32_bf16 v41, s6, v164
  v_dot2c_f32_bf16 v42, s6, v160
  v_dot2c_f32_bf16 v43, s6, v165
  v_dot2c_f32_bf16 v44, s6, v161
  v_dot2c_f32_bf16 v45, s6, v166
  v_dot2c_f32_bf16 v46, s6, v162
  v_dot2c_f32_bf16 v47, s6, v167
  v_dot2c_f32_bf16 v40, s7, v163
  v_dot2c_f32_bf16 v41, s7, v172
  v_dot2c_f32_bf16 v42, s7, v168
  v_dot2c_f32_bf16 v43, s7, v173
  v_dot2c_f32_bf16 v44, s7, v169
  v_dot2c_f32_bf16 v45, s7, v174
  v_dot2c_f32_bf16 v46, s7, v170
  v_dot2c_f32_bf16 v47, s7, v175
  v_cvt_pk_bf16_f32 v48, v40, v41
  v_cvt_pk_bf16_f32 v49, v42, v43
  v_cvt_pk_bf16_f32 v50, v44, v45
  v_cvt_pk_bf16_f32 v51, v46, v47
  global_store_dwordx4 v3, v[48:51], s[36:37] offset:-2048 sc1
L_noffn_109:
  s_barrier
  s_endpgm
L_o_over_90:
  s_sub_u32 s65, s65, 1
  s_cbranch_scc1 L_exit
  s_mov_b32 s58, 64
  s_waitcnt vmcnt(0)
  v_max3_u32 v48, v214, v215, v216
  v_max3_u32 v48, v48, v217, v218
  v_max3_u32 v48, v48, v219, v220
  v_max3_u32 v48, v48, v221, v221
  v_cmp_eq_u32 vcc, 0xffff0000, v48
  s_cbranch_vccnz L_o_89
  v_max3_u32 v48, v230, v231, v232
  v_max3_u32 v48, v48, v233, v234
  v_max3_u32 v48, v48, v235, v236
  v_max3_u32 v48, v48, v237, v237
  v_cmp_eq_u32 vcc, -1, v48
  s_cbranch_vccnz L_o_89
  s_branch L_ogen_88
L_ogen_88:
  s_waitcnt vmcnt(0)
  s_mov_b32 s58, 128000
L_omloop_93:
  s_sub_u32 s58, s58, 1
  s_cbranch_scc1 L_exit
  global_load_dwordx4 v[222:225], v9, s[46:47] offset:1024 sc1
  global_load_dwordx4 v[226:229], v9, s[46:47] offset:1040 sc1
  s_waitcnt vmcnt(0)
  v_cmp_gt_i32 vcc, 0, v230
  s_nop 1
  v_cndmask_b32 v64, 0, v222, vcc
  v_cmp_gt_i32 vcc, 0, v231
  s_nop 1
  v_cndmask_b32 v65, 0, v223, vcc
  v_cmp_gt_i32 vcc, 0, v232
  s_nop 1
  v_cndmask_b32 v66, 0, v224, vcc
  v_cmp_gt_i32 vcc, 0, v233
  s_nop 1
  v_cndmask_b32 v67, 0, v225, vcc
  v_cmp_gt_i32 vcc, 0, v234
  s_nop 1
  v_cndmask_b32 v68, 0, v226, vcc
  v_cmp_gt_i32 vcc, 0, v235
  s_nop 1
  v_cndmask_b32 v69, 0, v227, vcc
  v_cmp_gt_i32 vcc, 0, v236
  s_nop 1
  v_cndmask_b32 v70, 0, v228, vcc
  v_cmp_gt_i32 vcc, 0, v237
  s_nop 1
  v_cndmask_b32 v71, 0, v229, vcc
  v_max3_u32 v48, v64, v65, v66
  v_max3_u32 v48, v48, v67, v68
  v_max3_u32 v48, v48, v69, v70
  v_max3_u32 v48, v48, v71, v71
  v_cmp_eq_u32 vcc, -1, v48
  s_cbranch_vccnz L_omloop_93
  v_max3_f32 v48, v64, v65, v66
  v_max3_f32 v48, v48, v67, v68
  v_max3_f32 v48, v48, v69, v70
  v_max_f32 v48, v48, v71
  v_mov_b32 v49, v48
  s_nop 1
  v_permlane32_swap_b32 v48, v49
  v_max_f32 v48, v48, v49
  v_mov_b32 v49, v48
  s_nop 1
  v_permlane16_swap_b32 v48, v49
  v_max_f32 v48, v48, v49
  v_sub_f32 v64, v64, v48
  v_sub_f32 v65, v65, v48
  v_sub_f32 v66, v66, v48
  v_sub_f32 v67, v67, v48
  v_sub_f32 v68, v68, v48
  v_sub_f32 v69, v69, v48
  v_sub_f32 v70, v70, v48
  v_sub_f32 v71, v71, v48
  v_exp_f32 v64, v64
  v_exp_f32 v65, v65
  v_exp_f32 v66, v66
  v_exp_f32 v67, v67
  v_exp_f32 v68, v68
  v_exp_f32 v69, v69
  v_exp_f32 v70, v70
  v_exp_f32 v71, v71
  v_mul_f32 v20, v64, v214
  v_mul_f32_e64 v36, v64, |v230|
  v_fmac_f32 v20, v65, v215
  v_fma_f32 v36, v65, |v231|, v36
  v_fmac_f32 v20, v66, v216
  v_fma_f32 v36, v66, |v232|, v36
  v_fmac_f32 v20, v67, v217
  v_fma_f32 v36, v67, |v233|, v36
  v_fmac_f32 v20, v68, v218
  v_fma_f32 v36, v68, |v234|, v36
  v_fmac_f32 v20, v69, v219
  v_fma_f32 v36, v69, |v235|, v36
  v_fmac_f32 v20, v70, v220
  v_fma_f32 v36, v70, |v236|, v36
  v_fmac_f32 v20, v71, v221
  v_fma_f32 v36, v71, |v237|, v36
  v_mov_b32 v49, v36
  s_nop 1
  v_permlane32_swap_b32 v36, v49
  v_add_f32 v36, v36, v49
  v_mov_b32 v49, v36
  s_nop 1
  v_permlane16_swap_b32 v36, v49
  v_add_f32 v36, v36, v49
  v_mov_b32 v50, v20
  s_nop 1
  v_permlane32_swap_b32 v20, v50
  v_add_f32 v20, v20, v50
  v_mov_b32 v50, v20
  s_nop 1
  v_permlane16_swap_b32 v20, v50
  v_add_f32 v20, v20, v50
  v_rcp_f32 v36, v36
  s_nop 0
  v_mul_f32 v20, v20, v36
  s_nop 1
  v_mov_b32_dpp v48, v20 quad_perm:[1,0,3,2] row_mask:0xf bank_mask:0xf
  v_cvt_pk_bf16_f32 v16, v20, v48
  s_nop 1
  s_branch L_onorm_87
L_cs_over_98:
  s_sub_u32 s65, s65, 1
  s_cbranch_scc1 L_exit
  s_mov_b32 s58, 64
  s_waitcnt vmcnt(0)
  v_max3_u32 v48, v214, v215, v216
  v_max3_u32 v48, v48, v217, v218
  v_max3_u32 v48, v48, v219, v220
  v_max3_u32 v48, v48, v221, v221
  v_cmp_eq_u32 vcc, 0xffff0000, v48
  s_cbranch_vccnz L_cs_97
  s_waitcnt vmcnt(4)
  v_pk_add_f32 v[20:21], v[214:215], v[216:217]
  s_waitcnt vmcnt(0)
  v_pk_add_f32 v[22:23], v[218:219], v[220:221]
  v_pk_add_f32 v[20:21], v[20:21], v[22:23]
  v_add_f32 v20, v20, v21
  v_mov_b32 v48, v20
  s_nop 1
  v_permlane32_swap_b32 v20, v48
  v_add_f32 v20, v20, v48
  v_mov_b32 v48, v20
  s_branch L_cs_done_96
L_xretry_100:
  global_load_dwordx4 v[238:241], v8, s[46:47] offset:-2048 sc1
  s_nop 15
L_xretry_100_b:
  global_load_dwordx4 v[238:241], v8, s[46:47] offset:-2048 sc1
  s_sub_u32 s58, s58, 1
  s_cbranch_scc1 L_exit
  s_waitcnt vmcnt(1)
  v_max3_u32 v48, v238, v239, v240
  v_max_u32 v48, v48, v241
  v_cmp_eq_u32 vcc, -1, v48
  s_cbranch_vccnz L_xretry_100_b
  s_branch L_xok_101
L_gu_102:
  global_load_short_d16_hi v214, v2, s[36:37] offset:-2048 sc1
  global_load_short_d16_hi v215, v2, s[36:37] offset:-1792 sc1
  global_load_short_d16_hi v216, v2, s[36:37] offset:-1536 sc1
  global_load_short_d16_hi v217, v2, s[36:37] offset:-1280 sc1
  global_load_short_d16_hi v218, v2, s[36:37] offset:-1024 sc1
  global_load_short_d16_hi v219, v2, s[36:37] offset:-768 sc1
  global_load_short_d16_hi v220, v2, s[36:37] offset:-512 sc1
  global_load_short_d16_hi v221, v2, s[36:37] offset:-256 sc1
  s_sub_u32 s58, s58, 1
  s_cbranch_scc0 L_gu_102_c
  s_branch L_gu_over_103
L_gu_over_103:
  s_sub_u32 s65, s65, 1
  s_cbranch_scc1 L_exit
  s_mov_b32 s58, 64
  s_waitcnt vmcnt(0)
  v_max3_u32 v48, v214, v215, v216
  v_max3_u32 v48, v48, v217, v218
  v_max3_u32 v48, v48, v219, v220
  v_max3_u32 v48, v48, v221, v221
  v_cmp_eq_u32 vcc, 0xffff0000, v48
  s_cbranch_vccnz L_gu_102
  s_waitcnt vmcnt(4)
  v_pk_add_f32 v[20:21], v[214:215], v[216:217]
  s_waitcnt vmcnt(0)
  v_pk_add_f32 v[22:23], v[218:219], v[220:221]
  v_pk_add_f32 v[20:21], v[20:21], v[22:23]
  v_add_f32 v20, v20, v21
  v_mov_b32 v48, v20
  s_nop 1
  v_permlane32_swap_b32 v20, v48
  v_add_f32 v20, v20, v48
  v_mov_b32 v48, v20
  s_branch L_gu_done_99
L_o_over_107:
  s_sub_u32 s65, s65, 1
  s_cbranch_scc1 L_exit
  s_mov_b32 s58, 64
  s_waitcnt vmcnt(0)
  v_max3_u32 v48, v214, v215, v216
  v_max3_u32 v48, v48, v217, v218
  v_max3_u32 v48, v48, v219, v220
  v_max3_u32 v48, v48, v221, v221
  v_cmp_eq_u32 vcc, 0xffff0000, v48
  s_cbranch_vccnz L_o_106
  v_max3_u32 v48, v230, v231, v232
  v_max3_u32 v48, v48, v233, v234
  v_max3_u32 v48, v48, v235, v236
  v_max3_u32 v48, v48, v237, v237
  v_cmp_eq_u32 vcc, -1, v48
  s_cbranch_vccnz L_o_106
  s_branch L_ogen_105
L_ogen_105:
  s_waitcnt vmcnt(0)
  s_mov_b32 s58, 128000
L_omloop_108:
  s_sub_u32 s58, s58, 1
  s_cbranch_scc1 L_exit
  global_load_dwordx4 v[222:225], v9, s[46:47] offset:2048 sc1
  global_load_dwordx4 v[226:229], v9, s[46:47] offset:2064 sc1
  s_waitcnt vmcnt(0)
  v_cmp_gt_i32 vcc, 0, v230
  s_nop 1
  v_cndmask_b32 v64, 0, v222, vcc
  v_cmp_gt_i32 vcc, 0, v231
  s_nop 1
  v_cndmask_b32 v65, 0, v223, vcc
  v_cmp_gt_i32 vcc, 0, v232
  s_nop 1
  v_cndmask_b32 v66, 0, v224, vcc
  v_cmp_gt_i32 vcc, 0, v233
  s_nop 1
  v_cndmask_b32 v67, 0, v225, vcc
  v_cmp_gt_i32 vcc, 0, v234
  s_nop 1
  v_cndmask_b32 v68, 0, v226, vcc
  v_cmp_gt_i32 vcc, 0, v235
  s_nop 1
  v_cndmask_b32 v69, 0, v227, vcc
  v_cmp_gt_i32 vcc, 0, v236
  s_nop 1
  v_cndmask_b32 v70, 0, v228, vcc
  v_cmp_gt_i32 vcc, 0, v237
  s_nop 1
  v_cndmask_b32 v71, 0, v229, vcc
  v_max3_u32 v48, v64, v65, v66
  v_max3_u32 v48, v48, v67, v68
  v_max3_u32 v48, v48, v69, v70
  v_max3_u32 v48, v48, v71, v71
  v_cmp_eq_u32 vcc, -1, v48
  s_cbranch_vccnz L_omloop_108
  v_max3_f32 v48, v64, v65, v66
  v_max3_f32 v48, v48, v67, v68
  v_max3_f32 v48, v48, v69, v70
  v_max_f32 v48, v48, v71
  v_mov_b32 v49, v48
  s_nop 1
  v_permlane32_swap_b32 v48, v49
  v_max_f32 v48, v48, v49
  v_mov_b32 v49, v48
  s_nop 1
  v_permlane16_swap_b32 v48, v49
  v_max_f32 v48, v48, v49
  v_sub_f32 v64, v64, v48
  v_sub_f32 v65, v65, v48
  v_sub_f32 v66, v66, v48
  v_sub_f32 v67, v67, v48
  v_sub_f32 v68, v68, v48
  v_sub_f32 v69, v69, v48
  v_sub_f32 v70, v70, v48
  v_sub_f32 v71, v71, v48
  v_exp_f32 v64, v64
  v_exp_f32 v65, v65
  v_exp_f32 v66, v66
  v_exp_f32 v67, v67
  v_exp_f32 v68, v68
  v_exp_f32 v69, v69
  v_exp_f32 v70, v70
  v_exp_f32 v71, v71
  v_mul_f32 v20, v64, v214
  v_mul_f32_e64 v36, v64, |v230|
  v_fmac_f32 v20, v65, v215
  v_fma_f32 v36, v65, |v231|, v36
  v_fmac_f32 v20, v66, v216
  v_fma_f32 v36, v66, |v232|, v36
  v_fmac_f32 v20, v67, v217
  v_fma_f32 v36, v67, |v233|, v36
  v_fmac_f32 v20, v68, v218
  v_fma_f32 v36, v68, |v234|, v36
  v_fmac_f32 v20, v69, v219
  v_fma_f32 v36, v69, |v235|, v36
  v_fmac_f32 v20, v70, v220
  v_fma_f32 v36, v70, |v236|, v36
  v_fmac_f32 v20, v71, v221
  v_fma_f32 v36, v71, |v237|, v36
  v_mov_b32 v49, v36
  s_nop 1
  v_permlane32_swap_b32 v36, v49
  v_add_f32 v36, v36, v49
  v_mov_b32 v49, v36
  s_nop 1
  v_permlane16_swap_b32 v36, v49
  v_add_f32 v36, v36, v49
  v_mov_b32 v50, v20
  s_nop 1
  v_permlane32_swap_b32 v20, v50
  v_add_f32 v20, v20, v50
  v_mov_b32 v50, v20
  s_nop 1
  v_permlane16_swap_b32 v20, v50
  v_add_f32 v20, v20, v50
  v_rcp_f32 v36, v36
  s_nop 0
  v_mul_f32 v20, v20, v36
  s_nop 1
  v_mov_b32_dpp v48, v20 quad_perm:[1,0,3,2] row_mask:0xf bank_mask:0xf
  v_cvt_pk_bf16_f32 v16, v20, v48
  s_nop 1
  s_branch L_onorm_104
L_xretry_111:
  global_load_dwordx4 v[238:241], v8, s[46:47] offset:0 sc1
  s_nop 15
L_xretry_111_b:
  global_load_dwordx4 v[238:241], v8, s[46:47] offset:0 sc1
  s_sub_u32 s58, s58, 1
  s_cbranch_scc1 L_exit
  s_waitcnt vmcnt(1)
  v_max3_u32 v48, v238, v239, v240
  v_max_u32 v48, v48, v241
  v_cmp_eq_u32 vcc, -1, v48
  s_cbranch_vccnz L_xretry_111_b
  s_branch L_xok_112
L_gu_113:
  global_load_short_d16_hi v214, v2, s[36:37] offset:0 sc1
  global_load_short_d16_hi v215, v2, s[36:37] offset:256 sc1
  global_load_short_d16_hi v216, v2, s[36:37] offset:512 sc1
  global_load_short_d16_hi v217, v2, s[36:37] offset:768 sc1
  global_load_short_d16_hi v218, v2, s[36:37] offset:1024 sc1
  global_load_short_d16_hi v219, v2, s[36:37] offset:1280 sc1
  global_load_short_d16_hi v220, v2, s[36:37] offset:1536 sc1
  global_load_short_d16_hi v221, v2, s[36:37] offset:1792 sc1
  s_sub_u32 s58, s58, 1
  s_cbranch_scc0 L_gu_113_c
  s_branch L_gu_over_114
L_gu_over_114:
  s_sub_u32 s65, s65, 1
  s_cbranch_scc1 L_exit
  s_mov_b32 s58, 64
  s_waitcnt vmcnt(0)
  v_max3_u32 v48, v214, v215, v216
  v_max3_u32 v48, v48, v217, v218
  v_max3_u32 v48, v48, v219, v220
  v_max3_u32 v48, v48, v221, v221
  v_cmp_eq_u32 vcc, 0xffff0000, v48
  s_cbranch_vccnz L_gu_113
  s_waitcnt vmcnt(4)
  v_pk_add_f32 v[20:21], v[214:215], v[216:217]
  s_waitcnt vmcnt(0)
  v_pk_add_f32 v[22:23], v[218:219], v[220:221]
  v_pk_add_f32 v[20:21], v[20:21], v[22:23]
  v_add_f32 v20, v20, v21
  v_mov_b32 v48, v20
  s_nop 1
  v_permlane32_swap_b32 v20, v48
  v_add_f32 v20, v20, v48
  v_mov_b32 v48, v20
  s_branch L_gu_done_110
L_Xslow:
  s_mov_b32 exec_hi, 0x00ffffff
  global_store_dword v78, v72, s[46:47] offset:-4096 sc1
  s_mov_b64 exec, -1
  global_store_dwordx4 v15, v[72:75], s[36:37] offset:-2048 sc1
  s_waitcnt vmcnt(0)
  v_mov_b64 v[40:41], 0
  v_mov_b64 v[42:43], 0
  v_mov_b64 v[44:45], 0
  v_mov_b64 v[46:47], 0
  v_dot2c_f32_bf16_dpp v40, v16, v212 row_newbcast:0 row_mask:0xf bank_mask:0xf
  v_dot2c_f32_bf16_dpp v41, v16, v84 row_newbcast:0 row_mask:0xf bank_mask:0xf
  v_dot2c_f32_bf16_dpp v42, v16, v80 row_newbcast:0 row_mask:0xf bank_mask:0xf
  v_dot2c_f32_bf16_dpp v43, v16, v85 row_newbcast:0 row_mask:0xf bank_mask:0xf
  v_dot2c_f32_bf16_dpp v44, v16, v81 row_newbcast:0 row_mask:0xf bank_mask:0xf
  v_dot2c_f32_bf16_dpp v45, v16, v86 row_newbcast:0 row_mask:0xf bank_mask:0xf
  v_dot2c_f32_bf16_dpp v46, v16, v82 row_newbcast:0 row_mask:0xf bank_mask:0xf
  v_dot2c_f32_bf16_dpp v47, v16, v87 row_newbcast:0 row_mask:0xf bank_mask:0xf
  v_dot2c_f32_bf16_dpp v40, v16, v83 row_newbcast:1 row_mask:0xf bank_mask:0xf
  v_dot2c_f32_bf16_dpp v41, v16, v92 row_newbcast:1 row_mask:0xf bank_mask:0xf
  v_dot2c_f32_bf16_dpp v42, v16, v88 row_newbcast:1 row_mask:0xf bank_mask:0xf
  v_dot2c_f32_bf16_dpp v43, v16, v93 row_newbcast:1 row_mask:0xf bank_mask:0xf
  v_dot2c_f32_bf16_dpp v44, v16, v89 row_newbcast:1 row_mask:0xf bank_mask:0xf
  v_dot2c_f32_bf16_dpp v45, v16, v94 row_newbcast:1 row_mask:0xf bank_mask:0xf
  v_dot2c_f32_bf16_dpp v46, v16, v90 row_newbcast:1 row_mask:0xf bank_mask:0xf
  v_dot2c_f32_bf16_dpp v47, v16, v95 row_newbcast:1 row_mask:0xf bank_mask:0xf
  v_dot2c_f32_bf16_dpp v40, v16, v91 row_newbcast:2 row_mask:0xf bank_mask:0xf
  v_dot2c_f32_bf16_dpp v41, v16, v100 row_newbcast:2 row_mask:0xf bank_mask:0xf
  v_dot2c_f32_bf16_dpp v42, v16, v96 row_newbcast:2 row_mask:0xf bank_mask:0xf
  v_dot2c_f32_bf16_dpp v43, v16, v101 row_newbcast:2 row_mask:0xf bank_mask:0xf
  v_dot2c_f32_bf16_dpp v44, v16, v97 row_newbcast:2 row_mask:0xf bank_mask:0xf
  v_dot2c_f32_bf16_dpp v45, v16, v102 row_newbcast:2 row_mask:0xf bank_mask:0xf
  v_dot2c_f32_bf16_dpp v46, v16, v98 row_newbcast:2 row_mask:0xf bank_mask:0xf
  v_dot2c_f32_bf16_dpp v47, v16, v103 row_newbcast:2 row_mask:0xf bank_mask:0xf
  v_dot2c_f32_bf16_dpp v40, v16, v99 row_newbcast:3 row_mask:0xf bank_mask:0xf
  v_dot2c_f32_bf16_dpp v41, v16, v108 row_newbcast:3 row_mask:0xf bank_mask:0xf
  v_dot2c_f32_bf16_dpp v42, v16, v104 row_newbcast:3 row_mask:0xf bank_mask:0xf
  v_dot2c_f32_bf16_dpp v43, v16, v109 row_newbcast:3 row_mask:0xf bank_mask:0xf
  v_dot2c_f32_bf16_dpp v44, v16, v105 row_newbcast:3 row_mask:0xf bank_mask:0xf
  v_dot2c_f32_bf16_dpp v45, v16, v110 row_newbcast:3 row_mask:0xf bank_mask:0xf
  v_dot2c_f32_bf16_dpp v46, v16, v106 row_newbcast:3 row_mask:0xf bank_mask:0xf
  v_dot2c_f32_bf16_dpp v47, v16, v111 row_newbcast:3 row_mask:0xf bank_mask:0xf
  v_dot2c_f32_bf16_dpp v40, v16, v107 row_newbcast:4 row_mask:0xf bank_mask:0xf
  v_dot2c_f32_bf16_dpp v41, v16, v116 row_newbcast:4 row_mask:0xf bank_mask:0xf
  v_dot2c_f32_bf16_dpp v42, v16, v112 row_newbcast:4 row_mask:0xf bank_mask:0xf
  v_dot2c_f32_bf16_dpp v43, v16, v117 row_newbcast:4 row_mask:0xf bank_mask:0xf
  v_dot2c_f32_bf16_dpp v44, v16, v113 row_newbcast:4 row_mask:0xf bank_mask:0xf
  v_dot2c_f32_bf16_dpp v45, v16, v118 row_newbcast:4 row_mask:0xf bank_mask:0xf
  v_dot2c_f32_bf16_dpp v46, v16, v114 row_newbcast:4 row_mask:0xf bank_mask:0xf
  v_dot2c_f32_bf16_dpp v47, v16, v119 row_newbcast:4 row_mask:0xf bank_mask:0xf
  v_dot2c_f32_bf16_dpp v40, v16, v115 row_newbcast:5 row_mask:0xf bank_mask:0xf
  v_dot2c_f32_bf16_dpp v41, v16, v124 row_newbcast:5 row_mask:0xf bank_mask:0xf
  v_dot2c_f32_bf16_dpp v42, v16, v120 row_newbcast:5 row_mask:0xf bank_mask:0xf
  v_dot2c_f32_bf16_dpp v43, v16, v125 row_newbcast:5 row_mask:0xf bank_mask:0xf
  v_dot2c_f32_bf16_dpp v44, v16, v121 row_newbcast:5 row_mask:0xf bank_mask:0xf
  v_dot2c_f32_bf16_dpp v45, v16, v126 row_newbcast:5 row_mask:0xf bank_mask:0xf
  v_dot2c_f32_bf16_dpp v46, v16, v122 row_newbcast:5 row_mask:0xf bank_mask:0xf
  v_dot2c_f32_bf16_dpp v47, v16, v127 row_newbcast:5 row_mask:0xf bank_mask:0xf
  v_dot2c_f32_bf16_dpp v40, v16, v123 row_newbcast:6 row_mask:0xf bank_mask:0xf
  v_dot2c_f32_bf16_dpp v41, v16, v132 row_newbcast:6 row_mask:0xf bank_mask:0xf
  v_dot2c_f32_bf16_dpp v42, v16, v128 row_newbcast:6 row_mask:0xf bank_mask:0xf
  v_dot2c_f32_bf16_dpp v43, v16, v133 row_newbcast:6 row_mask:0xf bank_mask:0xf
  v_dot2c_f32_bf16_dpp v44, v16, v129 row_newbcast:6 row_mask:0xf bank_mask:0xf
  v_dot2c_f32_bf16_dpp v45, v16, v134 row_newbcast:6 row_mask:0xf bank_mask:0xf
  v_dot2c_f32_bf16_dpp v46, v16, v130 row_newbcast:6 row_mask:0xf bank_mask:0xf
  v_dot2c_f32_bf16_dpp v47, v16, v135 row_newbcast:6 row_mask:0xf bank_mask:0xf
  v_dot2c_f32_bf16_dpp v40, v16, v131 row_newbcast:7 row_mask:0xf bank_mask:0xf
  v_dot2c_f32_bf16_dpp v41, v16, v140 row_newbcast:7 row_mask:0xf bank_mask:0xf
  v_dot2c_f32_bf16_dpp v42, v16, v136 row_newbcast:7 row_mask:0xf bank_mask:0xf
  v_dot2c_f32_bf16_dpp v43, v16, v141 row_newbcast:7 row_mask:0xf bank_mask:0xf
  v_dot2c_f32_bf16_dpp v44, v16, v137 row_newbcast:7 row_mask:0xf bank_mask:0xf
  v_dot2c_f32_bf16_dpp v45, v16, v142 row_newbcast:7 row_mask:0xf bank_mask:0xf
  v_dot2c_f32_bf16_dpp v46, v16, v138 row_newbcast:7 row_mask:0xf bank_mask:0xf
  v_dot2c_f32_bf16_dpp v47, v16, v143 row_newbcast:7 row_mask:0xf bank_mask:0xf
  v_bfi_b32 v40, v1, s57, v40
  v_bfi_b32 v41, v1, s57, v41
  v_bfi_b32 v42, v1, s57, v42
  v_bfi_b32 v43, v1, s57, v43
  v_bfi_b32 v44, v1, s57, v44
  v_bfi_b32 v45, v1, s57, v45
  v_bfi_b32 v46, v1, s57, v46
  v_bfi_b32 v47, v1, s57, v47
  global_store_dwordx4 v3, v[40:43], s[36:37] offset:0 sc1
  global_store_dwordx4 v3, v[44:47], s[36:37] offset:2048 sc1
  s_add_u32 s3, s56, 1
  s_lshl_b32 s3, s3, 4
  s_add_u32 s32, s3, 16
  s_or_b32 s3, s3, s61
  s_add_u32 s24, s3, 16
  s_waitcnt vmcnt(0)
  v_mov_b32 v48, s24
  s_lshl_b32 s31, s29, 2
  v_mov_b32 v49, s31
  s_mov_b64 exec, 1
  global_store_dword v49, v48, s[46:47] offset:3072 sc1
  s_mov_b64 exec, -1
  s_mov_b32 s58, 128000
L_q0_115:
  global_load_dword v222, v209, s[36:37] offset:0 sc1
  global_load_dword v223, v209, s[36:37] offset:256 sc1
  global_load_dword v224, v209, s[36:37] offset:512 sc1
  global_load_dword v225, v209, s[36:37] offset:768 sc1
  global_load_dword v226, v209, s[36:37] offset:1024 sc1
  global_load_dword v227, v209, s[36:37] offset:1280 sc1
  global_load_dword v228, v209, s[36:37] offset:1536 sc1
  global_load_dword v229, v209, s[36:37] offset:1792 sc1
  global_load_dword v238, v253, s[46:47] offset:3072 sc1
  s_sub_u32 s58, s58, 1
  s_cbranch_scc1 L_exit
  s_waitcnt vmcnt(0)
  v_cmp_ne_u32 s[30:31], s3, v238
  v_cmp_ne_u32 vcc, s24, v238
  v_and_b32 v50, -16, v238
  s_nop 0
  s_and_b64 s[30:31], s[30:31], vcc
  v_cmp_ne_u32 vcc, s32, v50
  s_cmp_eq_u64 s[30:31], 0
  s_nop 0
  s_cselect_b64 s[30:31], 0, vcc
  v_xor_b32 v28, s57, v222
  v_xor_b32 v29, s57, v223
  v_xor_b32 v30, s57, v224
  v_xor_b32 v31, s57, v225
  v_xor_b32 v32, s57, v226
  v_xor_b32 v33, s57, v227
  v_xor_b32 v34, s57, v228
  v_xor_b32 v35, s57, v229
  v_or3_b32 v48, v28, v29, v30
  v_or3_b32 v48, v48, v31, v32
  v_or3_b32 v48, v48, v33, v34
  v_or_b32 v48, v48, v35
  v_cmp_ne_u32_sdwa vcc, v48, 0 src0_sel:BYTE_0 src1_sel:DWORD
  v_pk_add_f32 v[20:21], v[28:29], v[30:31]
  v_pk_add_f32 v[22:23], v[32:33], v[34:35]
  v_pk_add_f32 v[20:21], v[20:21], v[22:23]
  v_add_f32 v20, v20, v21
  s_or_b64 vcc, vcc, s[30:31]
  s_cbranch_vccnz L_q0_115
  v_mov_b32 v48, v20
  s_nop 1
  v_permlane32_swap_b32 v20, v48
  v_add_f32 v20, v20, v48
  v_mov_b32 v48, v20
  s_nop 1
  v_permlane16_swap_b32 v20, v48
  v_add_f32 v20, v20, v48
  v_mul_f32 v20, v20, v18
  s_nop 1
  v_mov_b32_dpp v48, v20 quad_perm:[1,0,3,2] row_mask:0xf bank_mask:0xf
  v_cvt_pk_bf16_f32 v16, v20, v48
  s_mov_b64 exec, 0x5555
  global_store_dword v7, v16, s[46:47] offset:-4096 sc1
  s_mov_b64 exec, -1
  global_store_dwordx4 v15, v[72:75], s[36:37] offset:0 sc1
  global_store_dwordx4 v15, v[72:75], s[36:37] offset:2048 sc1
  v_mov_b32 v49, 1
  ds_write_b32 v76, v49 offset:41088
  s_mov_b32 s58, 128000
  s_sleep 4
  global_load_dwordx4 v[238:241], v79, s[46:47] offset:-4096 sc1
  s_sleep 7
  global_load_dwordx4 v[238:241], v79, s[46:47] offset:-4096 sc1
  s_sleep 7
L_aq_117:
  global_load_dwordx4 v[238:241], v79, s[46:47] offset:-4096 sc1
  s_sub_u32 s58, s58, 1
  s_cbranch_scc1 L_exit
  s_sleep 3
  s_waitcnt vmcnt(2)
  v_max3_u32 v48, v238, v239, v240
  v_max_u32 v48, v48, v241
  v_cmp_eq_u32 vcc, -1, v48
  s_cbranch_vccnz L_aq_117
  ds_write_b128 v8, v[238:241] offset:41984
  s_waitcnt lgkmcnt(0)
  s_barrier
  v_mov_b64 v[222:223], 0
  v_mov_b64 v[224:225], 0
  v_mov_b64 v[226:227], 0
  v_mov_b64 v[228:229], 0
  v_lshrrev_b32 v48, 5, v0
  v_lshlrev_b32 v48, 16, v48
  v_add_u32 v48, v48, v6
  global_atomic_swap v48, v76, s[48:49]
  global_atomic_swap v48, v76, s[52:53]
  v_mov_b32 v68, s64
  v_mov_b32 v69, s64
  v_mov_b32 v70, s64
  v_mov_b32 v71, s64
  s_barrier
  ds_read_b128 v[48:51], v8 offset:32768
  ds_read_b128 v[52:55], v8 offset:33792
  ds_read_b128 v[56:59], v8 offset:34816
  ds_read_b128 v[60:63], v8 offset:35840
  ds_read_b128 v[64:67], v12
  s_waitcnt lgkmcnt(4)
  v_mfma_f32_16x16x32_bf16 v[20:23], v[48:51], v[68:71], 0
  s_waitcnt lgkmcnt(3)
  v_mfma_f32_16x16x32_bf16 v[20:23], v[52:55], v[68:71], v[20:23]
  s_waitcnt lgkmcnt(2)
  v_mfma_f32_16x16x32_bf16 v[20:23], v[56:59], v[68:71], v[20:23]
  s_waitcnt lgkmcnt(1)
  v_mfma_f32_16x16x32_bf16 v[20:23], v[60:63], v[68:71], v[20:23]
  s_waitcnt lgkmcnt(0)
  v_or3_b32 v28, v64, v65, v66
  v_or_b32 v28, v28, v67
  v_cmp_ne_u32 vcc, 0, v28
  s_cbranch_vccnz L_cgen_119
  s_mov_b32 exec_lo, 0x00020002
  s_mov_b32 exec_hi, 0x00020002
L_cback_120:
  s_nop 0
  global_store_dword v10, v20, s[46:47] offset:1024 sc1
  s_mov_b64 exec, -1
  s_barrier
  v_lshrrev_b32 v64, 1, v0
  v_lshlrev_b32 v64, 4, v64
  v_and_b32 v65, 1, v0
  v_lshl_add_u32 v64, v65, 9, v64
  v_add_u32 v64, 59392, v64
  s_mov_b32 s65, 512000
  v_mov_b64 v[40:41], 0
  v_mov_b64 v[42:43], 0
  v_mov_b64 v[44:45], 0
  v_mov_b64 v[46:47], 0
L_cnt_121:
  ds_read_b32 v49, v76 offset:41100
  s_sub_u32 s65, s65, 1
  s_cbranch_scc1 L_exit
  s_waitcnt lgkmcnt(0)
  v_cmp_gt_u32 vcc, 4, v49
  s_cbranch_vccnz L_cnt_121
  ds_read_b128 v[144:147], v64 offset:0
  ds_read_b128 v[148:151], v64 offset:1024
  ds_read_b128 v[152:155], v64 offset:2048
  ds_read_b128 v[156:159], v64 offset:3072
  ds_read_b128 v[160:163], v64 offset:4096
  ds_read_b128 v[164:167], v64 offset:5120
  ds_read_b128 v[168:171], v64 offset:6144
  ds_read_b128 v[172:175], v64 offset:7168
  ds_read_b128 v[176:179], v64 offset:8192
  ds_read_b128 v[180:183], v64 offset:9216
  s_waitcnt lgkmcnt(8)
  v_perm_b32 v139, v148, v144, s62
  v_perm_b32 v148, v148, v144, s63
  v_perm_b32 v144, v149, v145, s62
  v_perm_b32 v149, v149, v145, s63
  v_perm_b32 v145, v150, v146, s62
  v_perm_b32 v150, v150, v146, s63
  v_perm_b32 v146, v151, v147, s62
  v_perm_b32 v151, v151, v147, s63
  v_dot2c_f32_bf16 v40, s64, v139
  v_dot2c_f32_bf16 v41, s64, v148
  v_dot2c_f32_bf16 v42, s64, v144
  v_dot2c_f32_bf16 v43, s64, v149
  v_dot2c_f32_bf16 v44, s64, v145
  v_dot2c_f32_bf16 v45, s64, v150
  v_dot2c_f32_bf16 v46, s64, v146
  v_dot2c_f32_bf16 v47, s64, v151
  ds_read_b128 v[184:187], v64 offset:10240
  ds_read_b128 v[188:191], v64 offset:11264
  s_waitcnt lgkmcnt(8)
  v_perm_b32 v147, v156, v152, s62
  v_perm_b32 v156, v156, v152, s63
  v_perm_b32 v152, v157, v153, s62
  v_perm_b32 v157, v157, v153, s63
  v_perm_b32 v153, v158, v154, s62
  v_perm_b32 v158, v158, v154, s63
  v_perm_b32 v154, v159, v155, s62
  v_perm_b32 v159, v159, v155, s63
  v_dot2c_f32_bf16 v40, s64, v147
  v_dot2c_f32_bf16 v41, s64, v156
  v_dot2c_f32_bf16 v42, s64, v152
  v_dot2c_f32_bf16 v43, s64, v157
  v_dot2c_f32_bf16 v44, s64, v153
  v_dot2c_f32_bf16 v45, s64, v158
  v_dot2c_f32_bf16 v46, s64, v154
  v_dot2c_f32_bf16 v47, s64, v159
  ds_read_b128 v[192:195], v64 offset:12288
  ds_read_b128 v[196:199], v64 offset:13312
  s_waitcnt lgkmcnt(8)
  v_perm_b32 v155, v164, v160, s62
  v_perm_b32 v164, v164, v160, s63
  v_perm_b32 v160, v165, v161, s62
  v_perm_b32 v165, v165, v161, s63
  v_perm_b32 v161, v166, v162, s62
  v_perm_b32 v166, v166, v162, s63
  v_perm_b32 v162, v167, v163, s62
  v_perm_b32 v167, v167, v163, s63
  v_dot2c_f32_bf16 v40, s64, v155
  v_dot2c_f32_bf16 v41, s64, v164
  v_dot2c_f32_bf16 v42, s64, v160
  v_dot2c_f32_bf16 v43, s64, v165
  v_dot2c_f32_bf16 v44, s64, v161
  v_dot2c_f32_bf16 v45, s64, v166
  v_dot2c_f32_bf16 v46, s64, v162
  v_dot2c_f32_bf16 v47, s64, v167
  ds_read_b128 v[200:203], v64 offset:14336
  ds_read_b128 v[204:207], v64 offset:15360
  s_waitcnt lgkmcnt(8)
  v_perm_b32 v163, v172, v168, s62
  v_perm_b32 v172, v172, v168, s63
  v_perm_b32 v168, v173, v169, s62
  v_perm_b32 v173, v173, v169, s63
  v_perm_b32 v169, v174, v170, s62
  v_perm_b32 v174, v174, v170, s63
  v_perm_b32 v170, v175, v171, s62
  v_perm_b32 v175, v175, v171, s63
  v_dot2c_f32_bf16 v40, s64, v163
  v_dot2c_f32_bf16 v41, s64, v172
  v_dot2c_f32_bf16 v42, s64, v168
  v_dot2c_f32_bf16 v43, s64, v173
  v_dot2c_f32_bf16 v44, s64, v169
  v_dot2c_f32_bf16 v45, s64, v174
  v_dot2c_f32_bf16 v46, s64, v170
  v_dot2c_f32_bf16 v47, s64, v175
  s_waitcnt lgkmcnt(6)
  v_perm_b32 v171, v180, v176, s62
  v_perm_b32 v180, v180, v176, s63
  v_perm_b32 v176, v181, v177, s62
  v_perm_b32 v181, v181, v177, s63
  v_perm_b32 v177, v182, v178, s62
  v_perm_b32 v182, v182, v178, s63
  v_perm_b32 v178, v183, v179, s62
  v_perm_b32 v183, v183, v179, s63
  v_dot2c_f32_bf16 v40, s64, v171
  v_dot2c_f32_bf16 v41, s64, v180
  v_dot2c_f32_bf16 v42, s64, v176
  v_dot2c_f32_bf16 v43, s64, v181
  v_dot2c_f32_bf16 v44, s64, v177
  v_dot2c_f32_bf16 v45, s64, v182
  v_dot2c_f32_bf16 v46, s64, v178
  v_dot2c_f32_bf16 v47, s64, v183
  s_waitcnt lgkmcnt(4)
  v_perm_b32 v179, v188, v184, s62
  v_perm_b32 v188, v188, v184, s63
  v_perm_b32 v184, v189, v185, s62
  v_perm_b32 v189, v189, v185, s63
  v_perm_b32 v185, v190, v186, s62
  v_perm_b32 v190, v190, v186, s63
  v_perm_b32 v186, v191, v187, s62
  v_perm_b32 v191, v191, v187, s63
  v_dot2c_f32_bf16 v40, s64, v179
  v_dot2c_f32_bf16 v41, s64, v188
  v_dot2c_f32_bf16 v42, s64, v184
  v_dot2c_f32_bf16 v43, s64, v189
  v_dot2c_f32_bf16 v44, s64, v185
  v_dot2c_f32_bf16 v45, s64, v190
  v_dot2c_f32_bf16 v46, s64, v186
  v_dot2c_f32_bf16 v47, s64, v191
  s_waitcnt lgkmcnt(2)
  v_perm_b32 v187, v196, v192, s62
  v_perm_b32 v196, v196, v192, s63
  v_perm_b32 v192, v197, v193, s62
  v_perm_b32 v197, v197, v193, s63
  v_perm_b32 v193, v198, v194, s62
  v_perm_b32 v198, v198, v194, s63
  v_perm_b32 v194, v199, v195, s62
  v_perm_b32 v199, v199, v195, s63
  v_dot2c_f32_bf16 v40, s64, v187
  v_dot2c_f32_bf16 v41, s64, v196
  v_dot2c_f32_bf16 v42, s64, v192
  v_dot2c_f32_bf16 v43, s64, v197
  v_dot2c_f32_bf16 v44, s64, v193
  v_dot2c_f32_bf16 v45, s64, v198
  v_dot2c_f32_bf16 v46, s64, v194
  v_dot2c_f32_bf16 v47, s64, v199
  s_waitcnt lgkmcnt(0)
  v_perm_b32 v195, v204, v200, s62
  v_perm_b32 v204, v204, v200, s63
  v_perm_b32 v200, v205, v201, s62
  v_perm_b32 v205, v205, v201, s63
  v_perm_b32 v201, v206, v202, s62
  v_perm_b32 v206, v206, v202, s63
  v_perm_b32 v202, v207, v203, s62
  v_perm_b32 v207, v207, v203, s63
  v_dot2c_f32_bf16 v40, s64, v195
  v_dot2c_f32_bf16 v41, s64, v204
  v_dot2c_f32_bf16 v42, s64, v200
  v_dot2c_f32_bf16 v43, s64, v205
  v_dot2c_f32_bf16 v44, s64, v201
  v_dot2c_f32_bf16 v45, s64, v206
  v_dot2c_f32_bf16 v46, s64, v202
  v_dot2c_f32_bf16 v47, s64, v207
  v_cvt_pk_bf16_f32 v246, v40, v41
  v_cvt_pk_bf16_f32 v247, v42, v43
  v_cvt_pk_bf16_f32 v248, v44, v45
  v_cvt_pk_bf16_f32 v249, v46, v47
  v_mov_b64 v[40:41], 0
  v_mov_b64 v[42:43], 0
  v_mov_b64 v[44:45], 0
  v_mov_b64 v[46:47], 0
  s_add_u32 s57, s56, 11
  s_and_b32 s57, s57, 0x3f
  s_or_b32 s57, s57, 0x40
  s_barrier
  s_mov_b64 exec, s[14:15]
  global_store_dwordx4 v3, v[246:249], s[36:37] offset:2048 sc1
  s_mov_b64 exec, -1
  s_mov_b32 s65, 2000
  s_mov_b32 s58, 64
  s_nop 15
  s_nop 3
  global_load_short_d16_hi v214, v2, s[36:37] offset:0 sc1
  global_load_short_d16_hi v215, v2, s[36:37] offset:256 sc1
  global_load_short_d16_hi v216, v2, s[36:37] offset:512 sc1
  global_load_short_d16_hi v217, v2, s[36:37] offset:768 sc1
  global_load_short_d16_hi v218, v2, s[36:37] offset:1024 sc1
  global_load_short_d16_hi v219, v2, s[36:37] offset:1280 sc1
  global_load_short_d16_hi v220, v2, s[36:37] offset:1536 sc1
  global_load_short_d16_hi v221, v2, s[36:37] offset:1792 sc1
  s_nop 14
  global_load_short_d16_hi v214, v2, s[36:37] offset:0 sc1
  global_load_short_d16_hi v215, v2, s[36:37] offset:256 sc1
  global_load_short_d16_hi v216, v2, s[36:37] offset:512 sc1
  global_load_short_d16_hi v217, v2, s[36:37] offset:768 sc1
  global_load_short_d16_hi v218, v2, s[36:37] offset:1024 sc1
  global_load_short_d16_hi v219, v2, s[36:37] offset:1280 sc1
  global_load_short_d16_hi v220, v2, s[36:37] offset:1536 sc1
  global_load_short_d16_hi v221, v2, s[36:37] offset:1792 sc1
  s_nop 14
L_out_123:
  global_load_short_d16_hi v214, v2, s[36:37] offset:0 sc1
  global_load_short_d16_hi v215, v2, s[36:37] offset:256 sc1
  global_load_short_d16_hi v216, v2, s[36:37] offset:512 sc1
  global_load_short_d16_hi v217, v2, s[36:37] offset:768 sc1
  global_load_short_d16_hi v218, v2, s[36:37] offset:1024 sc1
  global_load_short_d16_hi v219, v2, s[36:37] offset:1280 sc1
  global_load_short_d16_hi v220, v2, s[36:37] offset:1536 sc1
  global_load_short_d16_hi v221, v2, s[36:37] offset:1792 sc1
  s_sub_u32 s58, s58, 1
  s_cbranch_scc1 L_out_over_124
  s_waitcnt vmcnt(20)
  v_pk_add_f32 v[20:21], v[214:215], v[216:217]
  s_waitcnt vmcnt(16)
  v_pk_add_f32 v[22:23], v[218:219], v[220:221]
  v_pk_add_f32 v[20:21], v[20:21], v[22:23]
  v_add_f32 v20, v20, v21
  v_mov_b32 v48, v20
  v_cmp_u_f32 vcc, v20, v20
  s_nop 0
  v_permlane32_swap_b32 v20, v48
  v_add_f32 v20, v20, v48
  v_mov_b32 v48, v20
  s_cbranch_vccnz L_out_123
L_out_done_122:
  s_nop 0
  v_permlane16_swap_b32 v20, v48
  v_add_f32 v20, v20, v48
  v_bfi_b32 v20, v1, s57, v20
  s_mov_b32 exec_hi, 0
  global_atomic_swap v6, v20, s[48:49]
  s_mov_b64 exec, -1
  global_store_dwordx4 v15, v[72:75], s[36:37] offset:0 sc1
  s_mov_b32 s58, 128000
  s_mov_b64 vcc, -1
  ds_read_b32 v48, v76 offset:41104
  s_lshr_b32 s30, s61, 2
  s_waitcnt lgkmcnt(0)
  v_readfirstlane_b32 s31, v48
  s_nop 1
  s_cmp_gt_i32 s31, 0
  s_cselect_b32 s31, 0, 1
  s_xor_b32 s30, s30, s31
  s_and_b32 s30, s30, 1
  s_lshl_b32 s30, s30, 13
  v_add_u32 v5, s30, v5
  global_atomic_or_x2 v[250:251], v5, v[76:77], s[48:49] sc0
  s_sleep 3
  global_atomic_or_x2 v[250:251], v5, v[76:77], s[48:49] sc0
  s_sleep 3
  global_atomic_or_x2 v[250:251], v5, v[76:77], s[48:49] sc0
  s_sleep 3
  global_atomic_or_x2 v[250:251], v5, v[76:77], s[48:49] sc0
L_g_126_c:
  s_waitcnt vmcnt(3)
  v_xor_b32 v20, s57, v250
  v_xor_b32 v21, s57, v251
  v_or_b32 v49, v20, v21
  v_cmp_ne_u32_sdwa vcc, v49, 0 src0_sel:BYTE_0 src1_sel:DWORD
  v_permlane32_swap_b32 v20, v21
  v_add_f32 v20, v20, v21
  v_mov_b32 v48, v20
  s_cbranch_vccnz L_g_126
  s_nop 0
  v_permlane16_swap_b32 v20, v48
  v_add_f32 v20, v20, v48
  s_nop 1
  v_add_f32_dpp v20, v20, v20 row_ror:8 row_mask:0xf bank_mask:0xf
  v_mov_b32 v21, v20
  s_nop 1
  v_permlane32_swap_b32 v20, v21
  v_add_f32 v20, v20, v13
  v_add_f32 v21, v21, v252
  v_cvt_pk_bf16_f32 v16, v20, v21
  s_mov_b64 exec, 0xff
  global_store_dword v254, v16, s[46:47] offset:-2048 sc1
  s_mov_b64 exec, -1
  s_barrier
  v_readlane_b32 s4, v16, 0
  v_readlane_b32 s5, v16, 1
  v_readlane_b32 s6, v16, 2
  v_dot2c_f32_bf16 v40, s4, v139
  v_dot2c_f32_bf16 v41, s4, v148
  v_readlane_b32 s7, v16, 3
  v_dot2c_f32_bf16 v42, s4, v144
  v_dot2c_f32_bf16 v43, s4, v149
  v_dot2c_f32_bf16 v44, s4, v145
  v_dot2c_f32_bf16 v45, s4, v150
  v_dot2c_f32_bf16 v46, s4, v146
  v_dot2c_f32_bf16 v47, s4, v151
  v_dot2c_f32_bf16 v40, s5, v147
  v_dot2c_f32_bf16 v41, s5, v156
  v_readlane_b32 s8, v16, 4
  v_dot2c_f32_bf16 v42, s5, v152
  v_dot2c_f32_bf16 v43, s5, v157
  v_dot2c_f32_bf16 v44, s5, v153
  v_dot2c_f32_bf16 v45, s5, v158
  v_dot2c_f32_bf16 v46, s5, v154
  v_dot2c_f32_bf16 v47, s5, v159
  v_dot2c_f32_bf16 v40, s6, v155
  v_dot2c_f32_bf16 v41, s6, v164
  v_readlane_b32 s9, v16, 5
  v_dot2c_f32_bf16 v42, s6, v160
  v_dot2c_f32_bf16 v43, s6, v165
  v_dot2c_f32_bf16 v44, s6, v161
  v_dot2c_f32_bf16 v45, s6, v166
  v_dot2c_f32_bf16 v46, s6, v162
  v_dot2c_f32_bf16 v47, s6, v167
  v_dot2c_f32_bf16 v40, s7, v163
  v_dot2c_f32_bf16 v41, s7, v172
  v_readlane_b32 s10, v16, 6
  v_dot2c_f32_bf16 v42, s7, v168
  v_dot2c_f32_bf16 v43, s7, v173
  v_dot2c_f32_bf16 v44, s7, v169
  v_dot2c_f32_bf16 v45, s7, v174
  v_dot2c_f32_bf16 v46, s7, v170
  v_dot2c_f32_bf16 v47, s7, v175
  v_dot2c_f32_bf16 v40, s8, v171
  v_dot2c_f32_bf16 v41, s8, v180
  v_readlane_b32 s11, v16, 7
  v_dot2c_f32_bf16 v42, s8, v176
  v_dot2c_f32_bf16 v43, s8, v181
  v_dot2c_f32_bf16 v44, s8, v177
  v_dot2c_f32_bf16 v45, s8, v182
  v_dot2c_f32_bf16 v46, s8, v178
  v_dot2c_f32_bf16 v47, s8, v183
  v_dot2c_f32_bf16 v40, s9, v179
  v_dot2c_f32_bf16 v41, s9, v188
  v_dot2c_f32_bf16 v42, s9, v184
  v_dot2c_f32_bf16 v43, s9, v189
  v_dot2c_f32_bf16 v44, s9, v185
  v_dot2c_f32_bf16 v45, s9, v190
  v_dot2c_f32_bf16 v46, s9, v186
  v_dot2c_f32_bf16 v47, s9, v191
  v_dot2c_f32_bf16 v40, s10, v187
  v_dot2c_f32_bf16 v41, s10, v196
  v_dot2c_f32_bf16 v42, s10, v192
  v_dot2c_f32_bf16 v43, s10, v197
  v_dot2c_f32_bf16 v44, s10, v193
  v_dot2c_f32_bf16 v45, s10, v198
  v_dot2c_f32_bf16 v46, s10, v194
  v_dot2c_f32_bf16 v47, s10, v199
  v_dot2c_f32_bf16 v40, s11, v195
  v_dot2c_f32_bf16 v41, s11, v204
  v_dot2c_f32_bf16 v42, s11, v200
  v_dot2c_f32_bf16 v43, s11, v205
  v_dot2c_f32_bf16 v44, s11, v201
  v_dot2c_f32_bf16 v45, s11, v206
  v_dot2c_f32_bf16 v46, s11, v202
  v_dot2c_f32_bf16 v47, s11, v207
  v_cvt_pk_bf16_f32 v48, v40, v41
  v_cvt_pk_bf16_f32 v49, v42, v43
  v_cvt_pk_bf16_f32 v50, v44, v45
  v_cvt_pk_bf16_f32 v51, v46, v47
  s_mov_b64 exec, s[14:15]
  global_store_dwordx4 v3, v[48:51], s[36:37] offset:-2048 sc1
  s_mov_b64 exec, -1
  v_lshlrev_b32 v13, 16, v16
  v_and_b32 v252, 0xffff0000, v16
  v_mov_b64 v[40:41], 0
  v_mov_b64 v[42:43], 0
  v_mov_b64 v[44:45], 0
  v_mov_b64 v[46:47], 0
  s_add_u32 s57, s56, 12
  s_and_b32 s57, s57, 0x3f
  s_or_b32 s57, s57, 0x40
  s_barrier
  s_mov_b32 s65, 2000
  s_mov_b32 s58, 64
  s_nop 15
  s_nop 3
  global_load_short_d16_hi v214, v2, s[36:37] offset:0 sc1
  global_load_short_d16_hi v215, v2, s[36:37] offset:256 sc1
  global_load_short_d16_hi v216, v2, s[36:37] offset:512 sc1
  global_load_short_d16_hi v217, v2, s[36:37] offset:768 sc1
  global_load_short_d16_hi v218, v2, s[36:37] offset:1024 sc1
  global_load_short_d16_hi v219, v2, s[36:37] offset:1280 sc1
  global_load_short_d16_hi v220, v2, s[36:37] offset:1536 sc1
  s_nop 14
  global_load_short_d16_hi v214, v2, s[36:37] offset:0 sc1
  global_load_short_d16_hi v215, v2, s[36:37] offset:256 sc1
  global_load_short_d16_hi v216, v2, s[36:37] offset:512 sc1
  global_load_short_d16_hi v217, v2, s[36:37] offset:768 sc1
  global_load_short_d16_hi v218, v2, s[36:37] offset:1024 sc1
  global_load_short_d16_hi v219, v2, s[36:37] offset:1280 sc1
  global_load_short_d16_hi v220, v2, s[36:37] offset:1536 sc1
  s_nop 14
L_out_128:
  global_load_short_d16_hi v214, v2, s[36:37] offset:0 sc1
  global_load_short_d16_hi v215, v2, s[36:37] offset:256 sc1
  global_load_short_d16_hi v216, v2, s[36:37] offset:512 sc1
  global_load_short_d16_hi v217, v2, s[36:37] offset:768 sc1
  global_load_short_d16_hi v218, v2, s[36:37] offset:1024 sc1
  global_load_short_d16_hi v219, v2, s[36:37] offset:1280 sc1
  global_load_short_d16_hi v220, v2, s[36:37] offset:1536 sc1
  s_sub_u32 s58, s58, 1
  s_cbranch_scc1 L_out_over_129
  s_waitcnt vmcnt(17)
  v_pk_add_f32 v[20:21], v[214:215], v[216:217]
  s_waitcnt vmcnt(14)
  v_pk_add_f32 v[20:21], v[20:21], v[218:219]
  v_add_f32 v20, v20, v220
  v_add_f32 v20, v20, v21
  v_mov_b32 v48, v20
  v_cmp_u_f32 vcc, v20, v20
  s_nop 0
  v_permlane32_swap_b32 v20, v48
  v_add_f32 v20, v20, v48
  v_mov_b32 v48, v20
  s_cbranch_vccnz L_out_128
L_out_done_127:
  s_nop 0
  v_permlane16_swap_b32 v20, v48
  v_add_f32 v20, v20, v48
  v_bfi_b32 v20, v1, s57, v20
  s_mov_b32 exec_hi, 0
  global_atomic_swap v6, v20, s[50:51]
  s_mov_b64 exec, -1
  global_store_dwordx4 v15, v[72:75], s[36:37] offset:0 sc1
  global_store_dwordx4 v3, v[242:245], s[36:37] offset:2048 sc1
  s_mov_b32 s58, 128000
  s_mov_b64 vcc, -1
  s_nop 15
  s_nop 3
  global_atomic_or_x2 v[250:251], v5, v[76:77], s[50:51] sc0
  s_sleep 3
  global_atomic_or_x2 v[250:251], v5, v[76:77], s[50:51] sc0
  s_sleep 3
  global_atomic_or_x2 v[250:251], v5, v[76:77], s[50:51] sc0
  s_sleep 3
  global_atomic_or_x2 v[250:251], v5, v[76:77], s[50:51] sc0
L_g_131_c:
  s_waitcnt vmcnt(3)
  v_xor_b32 v20, s57, v250
  v_xor_b32 v21, s57, v251
  v_or_b32 v49, v20, v21
  v_cmp_ne_u32_sdwa vcc, v49, 0 src0_sel:BYTE_0 src1_sel:DWORD
  v_permlane32_swap_b32 v20, v21
  v_add_f32 v20, v20, v21
  v_mov_b32 v48, v20
  s_cbranch_vccnz L_g_131
  s_nop 0
  v_permlane16_swap_b32 v20, v48
  v_add_f32 v20, v20, v48
  s_nop 1
  v_add_f32_dpp v20, v20, v20 row_ror:8 row_mask:0xf bank_mask:0xf
  v_mov_b32 v21, v20
  s_nop 1
  v_permlane32_swap_b32 v20, v21
  v_add_f32 v20, v20, v13
  v_add_f32 v21, v21, v252
  v_cvt_pk_bf16_f32 v16, v20, v21
  s_mov_b64 exec, 0xff
  global_store_dword v254, v16, s[46:47] offset:-1024 sc1
  s_mov_b64 exec, -1
  global_load_short_d16_hi v222, v2, s[36:37] offset:2048 sc1
  global_load_short_d16_hi v223, v2, s[36:37] offset:2304 sc1
  global_load_short_d16_hi v224, v2, s[36:37] offset:2560 sc1
  global_load_short_d16_hi v225, v2, s[36:37] offset:2816 sc1
  global_load_short_d16_hi v226, v2, s[36:37] offset:3072 sc1
  global_load_short_d16_hi v227, v2, s[36:37] offset:3328 sc1
  global_load_short_d16_hi v228, v2, s[36:37] offset:3584 sc1
  global_load_short_d16_hi v229, v2, s[36:37] offset:3840 sc1
  v_readlane_b32 s4, v16, 0
  v_readlane_b32 s5, v16, 1
  v_readlane_b32 s6, v16, 2
  v_dot2c_f32_bf16 v40, s4, v212
  v_dot2c_f32_bf16 v41, s4, v84
  v_readlane_b32 s7, v16, 3
  v_dot2c_f32_bf16 v42, s4, v80
  v_dot2c_f32_bf16 v43, s4, v85
  v_dot2c_f32_bf16 v44, s4, v81
  v_dot2c_f32_bf16 v45, s4, v86
  v_dot2c_f32_bf16 v46, s4, v82
  v_dot2c_f32_bf16 v47, s4, v87
  v_dot2c_f32_bf16 v40, s5, v83
  v_dot2c_f32_bf16 v41, s5, v92
  v_readlane_b32 s8, v16, 4
  v_dot2c_f32_bf16 v42, s5, v88
  v_dot2c_f32_bf16 v43, s5, v93
  v_dot2c_f32_bf16 v44, s5, v89
  v_dot2c_f32_bf16 v45, s5, v94
  v_dot2c_f32_bf16 v46, s5, v90
  v_dot2c_f32_bf16 v47, s5, v95
  v_dot2c_f32_bf16 v40, s6, v91
  v_dot2c_f32_bf16 v41, s6, v100
  v_readlane_b32 s9, v16, 5
  v_dot2c_f32_bf16 v42, s6, v96
  v_dot2c_f32_bf16 v43, s6, v101
  v_dot2c_f32_bf16 v44, s6, v97
  v_dot2c_f32_bf16 v45, s6, v102
  v_dot2c_f32_bf16 v46, s6, v98
  v_dot2c_f32_bf16 v47, s6, v103
  v_dot2c_f32_bf16 v40, s7, v99
  v_dot2c_f32_bf16 v41, s7, v108
  v_readlane_b32 s10, v16, 6
  v_dot2c_f32_bf16 v42, s7, v104
  v_dot2c_f32_bf16 v43, s7, v109
  v_dot2c_f32_bf16 v44, s7, v105
  v_dot2c_f32_bf16 v45, s7, v110
  v_dot2c_f32_bf16 v46, s7, v106
  v_dot2c_f32_bf16 v47, s7, v111
  v_dot2c_f32_bf16 v40, s8, v107
  v_dot2c_f32_bf16 v41, s8, v116
  v_readlane_b32 s11, v16, 7
  v_dot2c_f32_bf16 v42, s8, v112
  v_dot2c_f32_bf16 v43, s8, v117
  v_dot2c_f32_bf16 v44, s8, v113
  v_dot2c_f32_bf16 v45, s8, v118
  v_dot2c_f32_bf16 v46, s8, v114
  v_dot2c_f32_bf16 v47, s8, v119
  v_dot2c_f32_bf16 v40, s9, v115
  v_dot2c_f32_bf16 v41, s9, v124
  v_dot2c_f32_bf16 v42, s9, v120
  v_dot2c_f32_bf16 v43, s9, v125
  v_dot2c_f32_bf16 v44, s9, v121
  v_dot2c_f32_bf16 v45, s9, v126
  v_dot2c_f32_bf16 v46, s9, v122
  v_dot2c_f32_bf16 v47, s9, v127
  v_dot2c_f32_bf16 v40, s10, v123
  v_dot2c_f32_bf16 v41, s10, v132
  v_dot2c_f32_bf16 v42, s10, v128
  v_dot2c_f32_bf16 v43, s10, v133
  v_dot2c_f32_bf16 v44, s10, v129
  v_dot2c_f32_bf16 v45, s10, v134
  v_dot2c_f32_bf16 v46, s10, v130
  v_dot2c_f32_bf16 v47, s10, v135
  v_dot2c_f32_bf16 v40, s11, v131
  v_dot2c_f32_bf16 v41, s11, v140
  v_dot2c_f32_bf16 v42, s11, v136
  v_dot2c_f32_bf16 v43, s11, v141
  v_dot2c_f32_bf16 v44, s11, v137
  v_dot2c_f32_bf16 v45, s11, v142
  v_dot2c_f32_bf16 v46, s11, v138
  v_dot2c_f32_bf16 v47, s11, v143
  global_load_dwordx4 v[238:241], v8, s[46:47] offset:-1024 sc1
  v_cvt_pk_bf16_f32 v48, v40, v41
  v_cvt_pk_bf16_f32 v49, v42, v43
  v_cvt_pk_bf16_f32 v50, v44, v45
  v_cvt_pk_bf16_f32 v51, v46, v47
  global_store_dwordx4 v3, v[48:51], s[36:37] offset:-2048 sc1
  v_lshlrev_b32 v13, 16, v16
  v_and_b32 v252, 0xffff0000, v16
  s_mov_b32 s65, 2000
  s_mov_b32 s58, 128000
  v_mov_b64 v[52:53], 0
  v_mov_b32 v54, 0x3b000000
  v_mov_b32 v55, 0x3727c5ac
  s_nop 14
  global_load_dwordx4 v[238:241], v8, s[46:47] offset:-1024 sc1
  s_nop 14
  global_load_dwordx4 v[238:241], v8, s[46:47] offset:-1024 sc1
  s_waitcnt vmcnt(4)
L_lcs_137:
  v_pk_add_f32 v[20:21], v[222:223], v[224:225]
  v_pk_add_f32 v[22:23], v[226:227], v[228:229]
  v_max3_u32 v48, v222, v223, v224
  v_max3_u32 v48, v48, v225, v226
  v_max3_u32 v48, v48, v227, v228
  v_max3_u32 v48, v48, v229, v229
  v_cmp_eq_u32 vcc, 0xffff0000, v48
  v_pk_add_f32 v[20:21], v[20:21], v[22:23]
  v_add_f32 v14, v20, v21
  s_cbranch_vccnz L_lcs_again_138
  v_mov_b32 v48, v14
  s_nop 1
  v_permlane32_swap_b32 v14, v48
  v_add_f32 v14, v14, v48
  v_mov_b32 v48, v14
  s_nop 1
  v_permlane16_swap_b32 v14, v48
  v_add_f32 v14, v14, v48
  s_waitcnt vmcnt(3)
  v_max3_u32 v48, v238, v239, v240
  v_max_u32 v48, v48, v241
  v_cmp_eq_u32 vcc, -1, v48
  s_cbranch_vccz L_xok_134
  s_waitcnt vmcnt(1)
  v_max3_u32 v48, v238, v239, v240
  v_max_u32 v48, v48, v241
  v_cmp_eq_u32 vcc, -1, v48
  s_cbranch_vccz L_xok_134
  s_waitcnt vmcnt(0)
  v_max3_u32 v48, v238, v239, v240
  v_max_u32 v48, v48, v241
  v_cmp_eq_u32 vcc, -1, v48
  s_cbranch_vccnz L_xretry_133
L_xok_134:
  v_dot2c_f32_bf16 v52, s64, v238
  v_dot2c_f32_bf16 v53, v238, v238
  v_dot2c_f32_bf16 v52, s64, v239
  v_dot2c_f32_bf16 v53, v239, v239
  v_dot2c_f32_bf16 v52, s64, v240
  v_dot2c_f32_bf16 v53, v240, v240
  v_dot2c_f32_bf16 v52, s64, v241
  v_dot2c_f32_bf16 v53, v241, v241
  global_load_short_d16_hi v214, v2, s[36:37] offset:-2048 sc1
  global_load_short_d16_hi v215, v2, s[36:37] offset:-1792 sc1
  global_load_short_d16_hi v216, v2, s[36:37] offset:-1536 sc1
  v_permlane32_swap_b32 v52, v53
  v_add_f32 v52, v52, v53
  v_mov_b32 v53, v52
  global_load_short_d16_hi v217, v2, s[36:37] offset:-1280 sc1
  global_load_short_d16_hi v218, v2, s[36:37] offset:-1024 sc1
  v_permlane16_swap_b32 v52, v53
  v_add_f32 v52, v52, v53
  global_load_short_d16_hi v219, v2, s[36:37] offset:-768 sc1
  global_load_short_d16_hi v220, v2, s[36:37] offset:-512 sc1
  v_add_f32_dpp v52, v52, v52 row_ror:8 row_mask:0xf bank_mask:0xf
  global_load_short_d16_hi v221, v2, s[36:37] offset:-256 sc1
  global_load_short_d16_hi v214, v2, s[36:37] offset:-2048 sc1
  v_add_f32_dpp v52, v52, v52 row_ror:4 row_mask:0xf bank_mask:0xf
  global_load_short_d16_hi v215, v2, s[36:37] offset:-1792 sc1
  global_load_short_d16_hi v216, v2, s[36:37] offset:-1536 sc1
  v_add_f32_dpp v52, v52, v52 row_ror:2 row_mask:0xf bank_mask:0xf
  global_load_short_d16_hi v217, v2, s[36:37] offset:-1280 sc1
  global_load_short_d16_hi v218, v2, s[36:37] offset:-1024 sc1
  v_add_f32_dpp v52, v52, v52 row_ror:1 row_mask:0xf bank_mask:0xf
  global_load_short_d16_hi v219, v2, s[36:37] offset:-768 sc1
  v_readlane_b32 s30, v52, 0
  v_readlane_b32 s31, v52, 32
  global_load_short_d16_hi v220, v2, s[36:37] offset:-512 sc1
  v_mul_f32 v17, s30, v54
  v_fma_f32 v18, s31, v54, v55
  v_fma_f32 v18, -v17, v17, v18
  v_max_f32 v18, v18, v55
  v_rsq_f32 v18, v18
  global_load_short_d16_hi v221, v2, s[36:37] offset:-256 sc1
  s_mov_b32 s58, 64
  v_mul_f32 v19, v17, v18
  v_mul_f32_e64 v19, -v19, v14
L_q_135_c:
  s_waitcnt vmcnt(12)
  v_pk_add_f32 v[20:21], v[214:215], v[216:217]
  s_waitcnt vmcnt(8)
  v_pk_add_f32 v[22:23], v[218:219], v[220:221]
  v_pk_add_f32 v[20:21], v[20:21], v[22:23]
  v_add_f32 v20, v20, v21
  v_mov_b32 v48, v20
  v_cmp_u_f32 vcc, v20, v20
  s_nop 0
  v_permlane32_swap_b32 v20, v48
  v_add_f32 v20, v20, v48
  v_mov_b32 v48, v20
  s_cbranch_vccnz L_q_135
L_q_done_132:
  s_nop 0
  v_permlane16_swap_b32 v20, v48
  v_add_f32 v20, v20, v48
  v_fma_f32 v20, v20, v18, v19
  s_nop 1
  v_mov_b32_dpp v48, v20 quad_perm:[1,0,3,2] row_mask:0xf bank_mask:0xf
  v_cvt_pk_bf16_f32 v16, v20, v48
  s_mov_b64 exec, 0x5555
  global_store_dword v7, v16, s[46:47] offset:-3072 sc1
  s_mov_b64 exec, -1
  global_store_dwordx4 v15, v[72:75], s[36:37] offset:-2048 sc1
  s_mov_b32 s58, 128000
  s_nop 15
  s_nop 15
  global_load_dwordx4 v[238:241], v79, s[46:47] offset:-3072 sc1
  s_nop 12
  global_load_dwordx4 v[238:241], v79, s[46:47] offset:-3072 sc1
  s_nop 12
L_aq_139:
  global_load_dwordx4 v[238:241], v79, s[46:47] offset:-3072 sc1
  s_sub_u32 s58, s58, 1
  s_cbranch_scc1 L_exit
  s_waitcnt vmcnt(2)
  v_max3_u32 v48, v238, v239, v240
  v_max_u32 v48, v48, v241
  v_cmp_eq_u32 vcc, -1, v48
  s_cbranch_vccnz L_aq_139
  ds_write_b128 v8, v[238:241] offset:41984
  s_waitcnt lgkmcnt(0)
  s_barrier
  v_mov_b32 v68, s64
  v_mov_b32 v69, s64
  v_mov_b32 v70, s64
  v_mov_b32 v71, s64
  s_barrier
  ds_read_b128 v[48:51], v8 offset:32768
  ds_read_b128 v[52:55], v8 offset:33792
  ds_read_b128 v[56:59], v8 offset:34816
  ds_read_b128 v[60:63], v8 offset:35840
  ds_read_b128 v[64:67], v12
  s_waitcnt lgkmcnt(4)
  v_mfma_f32_16x16x32_bf16 v[20:23], v[48:51], v[68:71], 0
  s_waitcnt lgkmcnt(3)
  v_mfma_f32_16x16x32_bf16 v[20:23], v[52:55], v[68:71], v[20:23]
  s_waitcnt lgkmcnt(2)
  v_mfma_f32_16x16x32_bf16 v[20:23], v[56:59], v[68:71], v[20:23]
  s_waitcnt lgkmcnt(1)
  v_mfma_f32_16x16x32_bf16 v[20:23], v[60:63], v[68:71], v[20:23]
  s_waitcnt lgkmcnt(0)
  v_or3_b32 v28, v64, v65, v66
  v_or_b32 v28, v28, v67
  v_cmp_ne_u32 vcc, 0, v28
  s_cbranch_vccnz L_cgen_141
  s_mov_b32 exec_lo, 0x00020002
  s_mov_b32 exec_hi, 0x00020002
L_cback_142:
  s_nop 0
  global_store_dword v10, v20, s[46:47] offset:2048 sc1
  s_mov_b64 exec, -1
  s_barrier
  v_mov_b64 v[40:41], 0
  v_mov_b64 v[42:43], 0
  v_mov_b64 v[44:45], 0
  v_mov_b64 v[46:47], 0
  s_add_u32 s57, s56, 13
  s_and_b32 s57, s57, 0x3f
  s_or_b32 s57, s57, 0x40
  s_barrier
  s_mov_b32 s65, 2000
  s_mov_b32 s58, 64
  s_nop 15
  s_nop 3
  global_load_short_d16_hi v214, v2, s[36:37] offset:-2048 sc1
  global_load_short_d16_hi v215, v2, s[36:37] offset:-1792 sc1
  global_load_short_d16_hi v216, v2, s[36:37] offset:-1536 sc1
  global_load_short_d16_hi v217, v2, s[36:37] offset:-1280 sc1
  global_load_short_d16_hi v218, v2, s[36:37] offset:-1024 sc1
  global_load_short_d16_hi v219, v2, s[36:37] offset:-768 sc1
  global_load_short_d16_hi v220, v2, s[36:37] offset:-512 sc1
  global_load_short_d16_hi v221, v2, s[36:37] offset:-256 sc1
  s_nop 14
  global_load_short_d16_hi v214, v2, s[36:37] offset:-2048 sc1
  global_load_short_d16_hi v215, v2, s[36:37] offset:-1792 sc1
  global_load_short_d16_hi v216, v2, s[36:37] offset:-1536 sc1
  global_load_short_d16_hi v217, v2, s[36:37] offset:-1280 sc1
  global_load_short_d16_hi v218, v2, s[36:37] offset:-1024 sc1
  global_load_short_d16_hi v219, v2, s[36:37] offset:-768 sc1
  global_load_short_d16_hi v220, v2, s[36:37] offset:-512 sc1
  global_load_short_d16_hi v221, v2, s[36:37] offset:-256 sc1
  s_nop 14
L_out_144:
  global_load_short_d16_hi v214, v2, s[36:37] offset:-2048 sc1
  global_load_short_d16_hi v215, v2, s[36:37] offset:-1792 sc1
  global_load_short_d16_hi v216, v2, s[36:37] offset:-1536 sc1
  global_load_short_d16_hi v217, v2, s[36:37] offset:-1280 sc1
  global_load_short_d16_hi v218, v2, s[36:37] offset:-1024 sc1
  global_load_short_d16_hi v219, v2, s[36:37] offset:-768 sc1
  global_load_short_d16_hi v220, v2, s[36:37] offset:-512 sc1
  global_load_short_d16_hi v221, v2, s[36:37] offset:-256 sc1
  s_sub_u32 s58, s58, 1
  s_cbranch_scc1 L_out_over_145
  s_waitcnt vmcnt(20)
  v_pk_add_f32 v[20:21], v[214:215], v[216:217]
  s_waitcnt vmcnt(16)
  v_pk_add_f32 v[22:23], v[218:219], v[220:221]
  v_pk_add_f32 v[20:21], v[20:21], v[22:23]
  v_add_f32 v20, v20, v21
  v_mov_b32 v48, v20
  v_cmp_u_f32 vcc, v20, v20
  s_nop 0
  v_permlane32_swap_b32 v20, v48
  v_add_f32 v20, v20, v48
  v_mov_b32 v48, v20
  s_cbranch_vccnz L_out_144
L_out_done_143:
  s_nop 0
  v_permlane16_swap_b32 v20, v48
  v_add_f32 v20, v20, v48
  v_bfi_b32 v20, v1, s57, v20
  s_mov_b32 exec_hi, 0
  global_atomic_swap v6, v20, s[52:53]
  s_mov_b64 exec, -1
  global_store_dwordx4 v15, v[72:75], s[36:37] offset:-2048 sc1
  s_cmp_eq_u32 s2, 0
  s_cbranch_scc0 L_noep_147
  s_add_u32 s30, s56, 16
  v_mov_b32 v48, s30
  s_mov_b64 exec, 1
  global_store_dword v76, v48, s[26:27] sc1
  s_mov_b64 exec, -1
L_noep_147:
  s_mov_b32 s58, 128000
  s_mov_b64 vcc, -1
  s_nop 15
  s_nop 3
  global_atomic_or_x2 v[250:251], v5, v[76:77], s[52:53] sc0
  s_sleep 3
  global_atomic_or_x2 v[250:251], v5, v[76:77], s[52:53] sc0
  s_sleep 3
  global_atomic_or_x2 v[250:251], v5, v[76:77], s[52:53] sc0
  s_sleep 3
  global_atomic_or_x2 v[250:251], v5, v[76:77], s[52:53] sc0
L_g_148_c:
  s_waitcnt vmcnt(3)
  v_xor_b32 v20, s57, v250
  v_xor_b32 v21, s57, v251
  v_or_b32 v49, v20, v21
  v_cmp_ne_u32_sdwa vcc, v49, 0 src0_sel:BYTE_0 src1_sel:DWORD
  v_permlane32_swap_b32 v20, v21
  v_add_f32 v20, v20, v21
  v_mov_b32 v48, v20
  s_cbranch_vccnz L_g_148
  s_nop 0
  v_permlane16_swap_b32 v20, v48
  v_add_f32 v20, v20, v48
  s_nop 1
  v_add_f32_dpp v20, v20, v20 row_ror:8 row_mask:0xf bank_mask:0xf
  v_mov_b32 v21, v20
  s_nop 1
  v_permlane32_swap_b32 v20, v21
  v_add_f32 v20, v20, v13
  v_add_f32 v21, v21, v252
  v_cvt_pk_bf16_f32 v16, v20, v21
  s_mov_b64 exec, 0xff
  global_store_dword v254, v16, s[46:47] offset:0 sc1
  s_mov_b64 exec, -1
  s_barrier
  v_readlane_b32 s4, v16, 0
  v_readlane_b32 s5, v16, 1
  v_readlane_b32 s6, v16, 2
  v_dot2c_f32_bf16 v40, s4, v139
  v_dot2c_f32_bf16 v41, s4, v148
  v_readlane_b32 s7, v16, 3
  v_dot2c_f32_bf16 v42, s4, v144
  v_dot2c_f32_bf16 v43, s4, v149
  v_dot2c_f32_bf16 v44, s4, v145
  v_dot2c_f32_bf16 v45, s4, v150
  v_dot2c_f32_bf16 v46, s4, v146
  v_dot2c_f32_bf16 v47, s4, v151
  v_dot2c_f32_bf16 v40, s5, v147
  v_dot2c_f32_bf16 v41, s5, v156
  v_readlane_b32 s8, v16, 4
  v_dot2c_f32_bf16 v42, s5, v152
  v_dot2c_f32_bf16 v43, s5, v157
  v_dot2c_f32_bf16 v44, s5, v153
  v_dot2c_f32_bf16 v45, s5, v158
  v_dot2c_f32_bf16 v46, s5, v154
  v_dot2c_f32_bf16 v47, s5, v159
  v_dot2c_f32_bf16 v40, s6, v155
  v_dot2c_f32_bf16 v41, s6, v164
  v_readlane_b32 s9, v16, 5
  v_dot2c_f32_bf16 v42, s6, v160
  v_dot2c_f32_bf16 v43, s6, v165
  v_dot2c_f32_bf16 v44, s6, v161
  v_dot2c_f32_bf16 v45, s6, v166
  v_dot2c_f32_bf16 v46, s6, v162
  v_dot2c_f32_bf16 v47, s6, v167
  v_dot2c_f32_bf16 v40, s7, v163
  v_dot2c_f32_bf16 v41, s7, v172
  v_readlane_b32 s10, v16, 6
  v_dot2c_f32_bf16 v42, s7, v168
  v_dot2c_f32_bf16 v43, s7, v173
  v_dot2c_f32_bf16 v44, s7, v169
  v_dot2c_f32_bf16 v45, s7, v174
  v_dot2c_f32_bf16 v46, s7, v170
  v_dot2c_f32_bf16 v47, s7, v175
  v_dot2c_f32_bf16 v40, s8, v171
  v_dot2c_f32_bf16 v41, s8, v180
  v_readlane_b32 s11, v16, 7
  v_dot2c_f32_bf16 v42, s8, v176
  v_dot2c_f32_bf16 v43, s8, v181
  v_dot2c_f32_bf16 v44, s8, v177
  v_dot2c_f32_bf16 v45, s8, v182
  v_dot2c_f32_bf16 v46, s8, v178
  v_dot2c_f32_bf16 v47, s8, v183
  v_dot2c_f32_bf16 v40, s9, v179
  v_dot2c_f32_bf16 v41, s9, v188
  v_dot2c_f32_bf16 v42, s9, v184
  v_dot2c_f32_bf16 v43, s9, v189
  v_dot2c_f32_bf16 v44, s9, v185
  v_dot2c_f32_bf16 v45, s9, v190
  v_dot2c_f32_bf16 v46, s9, v186
  v_dot2c_f32_bf16 v47, s9, v191
  v_dot2c_f32_bf16 v40, s10, v187
  v_dot2c_f32_bf16 v41, s10, v196
  v_dot2c_f32_bf16 v42, s10, v192
  v_dot2c_f32_bf16 v43, s10, v197
  v_dot2c_f32_bf16 v44, s10, v193
  v_dot2c_f32_bf16 v45, s10, v198
  v_dot2c_f32_bf16 v46, s10, v194
  v_dot2c_f32_bf16 v47, s10, v199
  v_dot2c_f32_bf16 v40, s11, v195
  v_dot2c_f32_bf16 v41, s11, v204
  v_dot2c_f32_bf16 v42, s11, v200
  v_dot2c_f32_bf16 v43, s11, v205
  v_dot2c_f32_bf16 v44, s11, v201
  v_dot2c_f32_bf16 v45, s11, v206
  v_dot2c_f32_bf16 v46, s11, v202
  v_dot2c_f32_bf16 v47, s11, v207
  v_cvt_pk_bf16_f32 v48, v40, v41
  v_cvt_pk_bf16_f32 v49, v42, v43
  v_cvt_pk_bf16_f32 v50, v44, v45
  v_cvt_pk_bf16_f32 v51, v46, v47
  s_mov_b64 exec, s[14:15]
  global_store_dwordx4 v3, v[48:51], s[36:37] offset:0 sc1
  s_mov_b64 exec, -1
  v_lshlrev_b32 v13, 16, v16
  v_and_b32 v252, 0xffff0000, v16
  v_mov_b64 v[40:41], 0
  v_mov_b64 v[42:43], 0
  v_mov_b64 v[44:45], 0
  v_mov_b64 v[46:47], 0
  s_add_u32 s57, s56, 14
  s_and_b32 s57, s57, 0x3f
  s_or_b32 s57, s57, 0x40
  s_barrier
  v_and_b32 v64, 7, v0
  v_lshlrev_b32 v64, 3, v64
  s_mov_b64 s[24:25], 0xff
  s_lshl_b64 s[24:25], s[24:25], 32
  s_mov_b32 s65, 2000
  s_mov_b32 s58, 64
  s_nop 15
  s_nop 3
  global_load_short_d16_hi v214, v2, s[36:37] offset:-2048 sc1
  global_load_short_d16_hi v215, v2, s[36:37] offset:-1792 sc1
  global_load_short_d16_hi v216, v2, s[36:37] offset:-1536 sc1
  global_load_short_d16_hi v217, v2, s[36:37] offset:-1280 sc1
  global_load_short_d16_hi v218, v2, s[36:37] offset:-1024 sc1
  global_load_short_d16_hi v219, v2, s[36:37] offset:-768 sc1
  global_load_short_d16_hi v220, v2, s[36:37] offset:-512 sc1
  s_nop 14
  global_load_short_d16_hi v214, v2, s[36:37] offset:-2048 sc1
  global_load_short_d16_hi v215, v2, s[36:37] offset:-1792 sc1
  global_load_short_d16_hi v216, v2, s[36:37] offset:-1536 sc1
  global_load_short_d16_hi v217, v2, s[36:37] offset:-1280 sc1
  global_load_short_d16_hi v218, v2, s[36:37] offset:-1024 sc1
  global_load_short_d16_hi v219, v2, s[36:37] offset:-768 sc1
  global_load_short_d16_hi v220, v2, s[36:37] offset:-512 sc1
  s_nop 14
L_out_150:
  global_load_short_d16_hi v214, v2, s[36:37] offset:-2048 sc1
  global_load_short_d16_hi v215, v2, s[36:37] offset:-1792 sc1
  global_load_short_d16_hi v216, v2, s[36:37] offset:-1536 sc1
  global_load_short_d16_hi v217, v2, s[36:37] offset:-1280 sc1
  global_load_short_d16_hi v218, v2, s[36:37] offset:-1024 sc1
  global_load_short_d16_hi v219, v2, s[36:37] offset:-768 sc1
  global_load_short_d16_hi v220, v2, s[36:37] offset:-512 sc1
  s_sub_u32 s58, s58, 1
  s_cbranch_scc1 L_out_over_151
  s_waitcnt vmcnt(17)
  v_pk_add_f32 v[20:21], v[214:215], v[216:217]
  s_waitcnt vmcnt(14)
  v_pk_add_f32 v[20:21], v[20:21], v[218:219]
  v_add_f32 v20, v20, v220
  v_add_f32 v20, v20, v21
  v_mov_b32 v48, v20
  v_cmp_u_f32 vcc, v20, v20
  s_nop 0
  v_permlane32_swap_b32 v20, v48
  v_add_f32 v20, v20, v48
  v_mov_b32 v48, v20
  s_cbranch_vccnz L_out_150
L_out_done_149:
  s_cmp_eq_u32 s28, 4
  v_permlane16_swap_b32 v20, v48
  v_add_f32 v20, v20, v48
  v_bfi_b32 v20, v1, s57, v20
  s_cbranch_scc0 L_lastpub_152
  s_not_b64 vcc, s[24:25]
  s_mov_b64 exec, vcc
  global_atomic_or_x2 v[250:251], v5, v[76:77], s[54:55] sc0
  s_mov_b64 exec, -1
  ds_bpermute_b32 v66, v64, v20
  ds_bpermute_b32 v67, v64, v20 offset:4
  s_mov_b32 s58, 128000
  s_waitcnt lgkmcnt(0)
  s_mov_b64 exec, s[24:25]
  v_mov_b64 v[250:251], v[66:67]
  s_mov_b64 exec, -1
  s_nop 15
  s_nop 15
  s_nop 4
  s_mov_b64 exec, vcc
  global_atomic_or_x2 v[250:251], v5, v[76:77], s[54:55] sc0
  s_mov_b64 exec, -1
  s_nop 15
  s_nop 13
  s_mov_b64 exec, vcc
  global_atomic_or_x2 v[250:251], v5, v[76:77], s[54:55] sc0
  s_mov_b64 exec, -1
L_g_154_c:
  s_waitcnt vmcnt(2)
  v_xor_b32 v20, s57, v250
  v_xor_b32 v21, s57, v251
  v_or_b32 v49, v20, v21
  v_cmp_ne_u32_sdwa vcc, v49, 0 src0_sel:BYTE_0 src1_sel:DWORD
  v_permlane32_swap_b32 v20, v21
  v_add_f32 v20, v20, v21
  v_mov_b32 v48, v20
  s_cbranch_vccnz L_g_154
  s_nop 0
  v_permlane16_swap_b32 v20, v48
  v_add_f32 v20, v20, v48
  s_nop 1
  v_add_f32_dpp v20, v20, v20 row_ror:8 row_mask:0xf bank_mask:0xf
  v_mov_b32 v21, v20
  s_nop 1
  v_permlane32_swap_b32 v20, v21
  v_add_f32 v20, v20, v13
  v_add_f32 v21, v21, v252
  v_cvt_pk_bf16_f32 v16, v20, v21
  s_mov_b64 exec, 0xff
  global_store_dword v254, v16, s[22:23] offset:0
  s_mov_b64 exec, -1
L_fin_153:
  s_endpgm
L_cgen_119:
  s_nop 7
  v_mfma_f32_16x16x32_bf16 v[28:31], v[48:51], v[68:71], 0
  v_mfma_f32_16x16x32_bf16 v[32:35], v[52:55], v[68:71], 0
  v_mfma_f32_16x16x32_bf16 v[40:43], v[56:59], v[68:71], 0
  v_mfma_f32_16x16x32_bf16 v[44:47], v[60:63], v[68:71], 0
  v_max3_f32 v20, v64, v65, v66
  v_max_f32 v20, v20, v67
  v_sub_f32 v64, v64, v20
  v_sub_f32 v65, v65, v20
  v_sub_f32 v66, v66, v20
  v_sub_f32 v67, v67, v20
  v_exp_f32 v64, v64
  v_exp_f32 v65, v65
  v_exp_f32 v66, v66
  v_exp_f32 v67, v67
  v_mul_f32 v21, v64, v28
  v_fmac_f32 v21, v65, v32
  v_fmac_f32 v21, v66, v40
  v_fmac_f32 v21, v67, v44
  v_or_b32 v21, 0x80000000, v21
  v_cndmask_b32 v20, v20, v21, s[66:67]
  s_mov_b32 exec_lo, 0x00030003
  s_mov_b32 exec_hi, 0x00030003
  s_branch L_cback_120
L_out_over_124:
  s_sub_u32 s65, s65, 1
  s_cbranch_scc1 L_exit
  s_mov_b32 s58, 64
  s_waitcnt vmcnt(0)
  v_max3_u32 v48, v214, v215, v216
  v_max3_u32 v48, v48, v217, v218
  v_max3_u32 v48, v48, v219, v220
  v_max3_u32 v48, v48, v221, v221
  v_cmp_eq_u32 vcc, 0xffff0000, v48
  s_cbranch_vccnz L_out_123
  s_waitcnt vmcnt(4)
  v_pk_add_f32 v[20:21], v[214:215], v[216:217]
  s_waitcnt vmcnt(0)
  v_pk_add_f32 v[22:23], v[218:219], v[220:221]
  v_pk_add_f32 v[20:21], v[20:21], v[22:23]
  v_add_f32 v20, v20, v21
  v_mov_b32 v48, v20
  s_nop 1
  v_permlane32_swap_b32 v20, v48
  v_add_f32 v20, v20, v48
  v_mov_b32 v48, v20
  s_branch L_out_done_122
L_g_126:
  s_mov_b64 exec, vcc
  global_atomic_or_x2 v[250:251], v5, v[76:77], s[48:49] sc0
  s_mov_b64 exec, -1
  s_sub_u32 s58, s58, 1
  s_cbranch_scc0 L_g_126_c
  s_endpgm
L_out_over_129:
  s_sub_u32 s65, s65, 1
  s_cbranch_scc1 L_exit
  s_mov_b32 s58, 64
  s_waitcnt vmcnt(0)
  v_max3_u32 v48, v214, v215, v216
  v_max3_u32 v48, v48, v217, v218
  v_max3_u32 v48, v48, v219, v220
  v_cmp_eq_u32 vcc, 0xffff0000, v48
  s_cbranch_vccnz L_out_128
  s_waitcnt vmcnt(3)
  v_pk_add_f32 v[20:21], v[214:215], v[216:217]
  s_waitcnt vmcnt(0)
  v_pk_add_f32 v[20:21], v[20:21], v[218:219]
  v_add_f32 v20, v20, v220
  v_add_f32 v20, v20, v21
  v_mov_b32 v48, v20
  s_nop 1
  v_permlane32_swap_b32 v20, v48
  v_add_f32 v20, v20, v48
  v_mov_b32 v48, v20
  s_branch L_out_done_127
L_g_131:
  s_mov_b64 exec, vcc
  global_atomic_or_x2 v[250:251], v5, v[76:77], s[50:51] sc0
  s_mov_b64 exec, -1
  s_sub_u32 s58, s58, 1
  s_cbranch_scc0 L_g_131_c
  s_endpgm
L_lcs_again_138:
  global_load_short_d16_hi v222, v2, s[36:37] offset:2048 sc1
  global_load_short_d16_hi v223, v2, s[36:37] offset:2304 sc1
  global_load_short_d16_hi v224, v2, s[36:37] offset:2560 sc1
  global_load_short_d16_hi v225, v2, s[36:37] offset:2816 sc1
  global_load_short_d16_hi v226, v2, s[36:37] offset:3072 sc1
  global_load_short_d16_hi v227, v2, s[36:37] offset:3328 sc1
  global_load_short_d16_hi v228, v2, s[36:37] offset:3584 sc1
  global_load_short_d16_hi v229, v2, s[36:37] offset:3840 sc1
  s_waitcnt vmcnt(0)
  s_sub_u32 s58, s58, 1
  s_cbranch_scc0 L_lcs_137
  s_endpgm
L_xretry_133:
  global_load_dwordx4 v[238:241], v8, s[46:47] offset:-1024 sc1
  s_nop 15
L_xretry_133_b:
  global_load_dwordx4 v[238:241], v8, s[46:47] offset:-1024 sc1
  s_sub_u32 s58, s58, 1
  s_cbranch_scc1 L_exit
  s_waitcnt vmcnt(1)
  v_max3_u32 v48, v238, v239, v240
  v_max_u32 v48, v48, v241
  v_cmp_eq_u32 vcc, -1, v48
  s_cbranch_vccnz L_xretry_133_b
  s_branch L_xok_134
L_q_135:
  global_load_short_d16_hi v214, v2, s[36:37] offset:-2048 sc1
  global_load_short_d16_hi v215, v2, s[36:37] offset:-1792 sc1
  global_load_short_d16_hi v216, v2, s[36:37] offset:-1536 sc1
  global_load_short_d16_hi v217, v2, s[36:37] offset:-1280 sc1
  global_load_short_d16_hi v218, v2, s[36:37] offset:-1024 sc1
  global_load_short_d16_hi v219, v2, s[36:37] offset:-768 sc1
  global_load_short_d16_hi v220, v2, s[36:37] offset:-512 sc1
  global_load_short_d16_hi v221, v2, s[36:37] offset:-256 sc1
  s_sub_u32 s58, s58, 1
  s_cbranch_scc0 L_q_135_c
  s_branch L_q_over_136
L_q_over_136:
  s_sub_u32 s65, s65, 1
  s_cbranch_scc1 L_exit
  s_mov_b32 s58, 64
  s_waitcnt vmcnt(0)
  v_max3_u32 v48, v214, v215, v216
  v_max3_u32 v48, v48, v217, v218
  v_max3_u32 v48, v48, v219, v220
  v_max3_u32 v48, v48, v221, v221
  v_cmp_eq_u32 vcc, 0xffff0000, v48
  s_cbranch_vccnz L_q_135
  s_waitcnt vmcnt(4)
  v_pk_add_f32 v[20:21], v[214:215], v[216:217]
  s_waitcnt vmcnt(0)
  v_pk_add_f32 v[22:23], v[218:219], v[220:221]
  v_pk_add_f32 v[20:21], v[20:21], v[22:23]
  v_add_f32 v20, v20, v21
  v_mov_b32 v48, v20
  s_nop 1
  v_permlane32_swap_b32 v20, v48
  v_add_f32 v20, v20, v48
  v_mov_b32 v48, v20
  s_branch L_q_done_132
L_cgen_141:
  s_nop 7
  v_mfma_f32_16x16x32_bf16 v[28:31], v[48:51], v[68:71], 0
  v_mfma_f32_16x16x32_bf16 v[32:35], v[52:55], v[68:71], 0
  v_mfma_f32_16x16x32_bf16 v[40:43], v[56:59], v[68:71], 0
  v_mfma_f32_16x16x32_bf16 v[44:47], v[60:63], v[68:71], 0
  v_max3_f32 v20, v64, v65, v66
  v_max_f32 v20, v20, v67
  v_sub_f32 v64, v64, v20
  v_sub_f32 v65, v65, v20
  v_sub_f32 v66, v66, v20
  v_sub_f32 v67, v67, v20
  v_exp_f32 v64, v64
  v_exp_f32 v65, v65
  v_exp_f32 v66, v66
  v_exp_f32 v67, v67
  v_mul_f32 v21, v64, v28
  v_fmac_f32 v21, v65, v32
  v_fmac_f32 v21, v66, v40
  v_fmac_f32 v21, v67, v44
  v_or_b32 v21, 0x80000000, v21
  v_cndmask_b32 v20, v20, v21, s[66:67]
  s_mov_b32 exec_lo, 0x00030003
  s_mov_b32 exec_hi, 0x00030003
  s_branch L_cback_142
L_out_over_145:
  s_sub_u32 s65, s65, 1
  s_cbranch_scc1 L_exit
  s_mov_b32 s58, 64
  s_waitcnt vmcnt(0)
  v_max3_u32 v48, v214, v215, v216
  v_max3_u32 v48, v48, v217, v218
  v_max3_u32 v48, v48, v219, v220
  v_max3_u32 v48, v48, v221, v221
  v_cmp_eq_u32 vcc, 0xffff0000, v48
  s_cbranch_vccnz L_out_144
  s_waitcnt vmcnt(4)
  v_pk_add_f32 v[20:21], v[214:215], v[216:217]
  s_waitcnt vmcnt(0)
  v_pk_add_f32 v[22:23], v[218:219], v[220:221]
  v_pk_add_f32 v[20:21], v[20:21], v[22:23]
  v_add_f32 v20, v20, v21
  v_mov_b32 v48, v20
  s_nop 1
  v_permlane32_swap_b32 v20, v48
  v_add_f32 v20, v20, v48
  v_mov_b32 v48, v20
  s_branch L_out_done_143
L_g_148:
  s_mov_b64 exec, vcc
  global_atomic_or_x2 v[250:251], v5, v[76:77], s[52:53] sc0
  s_mov_b64 exec, -1
  s_sub_u32 s58, s58, 1
  s_cbranch_scc0 L_g_148_c
  s_endpgm
L_out_over_151:
  s_sub_u32 s65, s65, 1
  s_cbranch_scc1 L_exit
  s_mov_b32 s58, 64
  s_waitcnt vmcnt(0)
  v_max3_u32 v48, v214, v215, v216
  v_max3_u32 v48, v48, v217, v218
  v_max3_u32 v48, v48, v219, v220
  v_cmp_eq_u32 vcc, 0xffff0000, v48
  s_cbranch_vccnz L_out_150
  s_waitcnt vmcnt(3)
  v_pk_add_f32 v[20:21], v[214:215], v[216:217]
  s_waitcnt vmcnt(0)
  v_pk_add_f32 v[20:21], v[20:21], v[218:219]
  v_add_f32 v20, v20, v220
  v_add_f32 v20, v20, v21
  v_mov_b32 v48, v20
  s_nop 1
  v_permlane32_swap_b32 v20, v48
  v_add_f32 v20, v20, v48
  v_mov_b32 v48, v20
  s_branch L_out_done_149
L_lastpub_152:
  s_mov_b32 exec_hi, 0
  global_atomic_swap v6, v20, s[54:55]
  s_mov_b64 exec, -1
  s_endpgm
L_g_154:
  s_mov_b64 exec, vcc
  global_atomic_or_x2 v[250:251], v5, v[76:77], s[54:55] sc0
  s_mov_b64 exec, -1
  s_sub_u32 s58, s58, 1
  s_cbranch_scc0 L_g_154_c
  s_endpgm
L_exit:
  s_endpgm

.section .rodata,"a"
.p2align 6
.amdhsa_kernel interleave_layers__sliding_block_cached__glu_gated_bilinear__decode_kernel
  .amdhsa_next_free_vgpr 256
  .amdhsa_next_free_sgpr 102
  .amdhsa_accum_offset 256
  .amdhsa_group_segment_fixed_size 0
  .amdhsa_kernarg_size 96
  .amdhsa_user_sgpr_count 2
  .amdhsa_user_sgpr_kernarg_segment_ptr 1
  .amdhsa_system_sgpr_workgroup_id_x 1
  .amdhsa_float_denorm_mode_32 3
.end_amdhsa_kernel
```
